```python
import torch

def _softmax(x, axis=-1):
    return torch.softmax(x, dim=axis)
def _gelu(x):
    return torch.nn.functional.gelu(x, approximate="tanh")
def _silu(x):
    return torch.nn.functional.silu(x)
def _sigmoid(x):
    return torch.sigmoid(x)
def _layernorm(x, axis=-1, eps=1e-5):
    m = x.mean(dim=axis, keepdim=True)
    v = x.var(dim=axis, keepdim=True, unbiased=False)
    return (x - m) / torch.sqrt(v + eps)
def _scatter_add(tgt, idx, src, axis=0):
    return tgt.clone().index_add_(axis, idx, src)
def _segment_sum(src, seg, n):
    out = torch.zeros((n,) + src.shape[1:], dtype=src.dtype)
    return out.index_add_(0, seg, src)
def _pad(x, pw):
    flat = tuple(v for pair in reversed(pw) for v in pair)
    return torch.nn.functional.pad(x, flat)

kernel_name = 'gather_scatter__molecular_angular_gemnet__graph'

def setup_inputs():

    _w = (lambda a: (lambda t: t.to(torch.bfloat16) if t.is_floating_point() else t)(torch.as_tensor(a)))
    N, deg, De, L = 10000, 32, 16, 3
    E = N * deg
    T = E * deg
    NR = 8
    dist = torch.rand(E).to(float)
    angle = (torch.rand(T) * torch.pi).to(float)
    centers = torch.linspace(0.0, 1.0, NR).to(float)
    ang_freq = torch.arange(1, L + 1).to(float)
    return {
        "m": _w((lambda *s: torch.randn(*s, dtype=torch.bfloat16) * 0.05)(E, De)),
        "idx_in": _w((lambda lo, hi, *s: torch.randint(lo, hi, s))(0, E, T).to(torch.int64)),
        "idx_out": _w((lambda lo, hi, *s: torch.randint(lo, hi, s))(0, E, T).to(torch.int64)),
        "dist": _w(dist),
        "angle": _w(angle),
        "centers": _w(centers),
        "ang_freq": _w(ang_freq),
        "w_rbf": _w((lambda *s: torch.randn(*s, dtype=torch.bfloat16) * 0.2)(NR, De)),
        "w_sbf": _w((lambda *s: torch.randn(*s, dtype=torch.bfloat16) * 0.2)(NR * L, De)),
        "w_down": _w((lambda *s: torch.randn(*s, dtype=torch.bfloat16) * 0.2)(De, De)),
        "w_up": _w((lambda *s: torch.randn(*s, dtype=torch.bfloat16) * 0.2)(De, De)),
    }

def reference(m, idx_in, idx_out, dist, angle, centers, ang_freq, w_rbf, w_sbf, w_down, w_up):
    E, De = m.shape[0], m.shape[1]
    NR = centers.shape[0]
    L = ang_freq.shape[0]
    rbf = torch.exp(-10.0 * (dist[:, None] - centers[None, :]) ** 2)
    cbf = torch.cos(ang_freq[None, :] * angle[:, None])
    rbf_t = rbf[idx_out]
    sbf = torch.reshape(rbf_t[:, :, None] * cbf[:, None, :], (-1, NR * L))
    x = (m[idx_in] @ w_down) * (sbf @ w_sbf)
    agg = _segment_sum(x, idx_out, E)
    return m + (agg @ w_up) * (rbf @ w_rbf)
```

```asm
; @launch kernel=partition_kernel grid=(250,1,1) block=(1024,1,1) lds=151808
; @launch kernel=consume_kernel grid=(500,1,1) block=(512,1,1) lds=79552
.amdgcn_target "amdgcn-amd-amdhsa--gfx950"
.text
.globl partition_kernel
.p2align 8
.type partition_kernel,@function
partition_kernel:
    s_cmp_ge_u32 s2, 250
    s_cbranch_scc1 L_p1_end
    s_load_dwordx4 s[4:7], s[0:1], 8
    s_load_dwordx2 s[8:9], s[0:1], 32
    s_load_dwordx2 s[10:11], s[0:1], 104
    v_lshlrev_b32 v1, 4, v0
    v_lshlrev_b32 v2, 3, v0
    s_mul_i32 s32, s2, 163840
    s_mul_i32 s33, s2, 81920
    s_mul_i32 s34, s2, 261120
    s_waitcnt lgkmcnt(0)
    s_add_u32 s12, s4, s32
    s_addc_u32 s13, s5, 0
    s_mov_b32 s14, 163840
    s_mov_b32 s15, 0x00020000
    s_add_u32 s16, s6, s32
    s_addc_u32 s17, s7, 0
    s_mov_b32 s18, 163840
    s_mov_b32 s19, 0x00020000
    s_add_u32 s20, s8, s33
    s_addc_u32 s21, s9, 0
    s_mov_b32 s22, 81920
    s_mov_b32 s23, 0x00020000
    v_mov_b32 v4, 0
    v_mov_b32 v5, 0
    ds_write_b64 v2, v[4:5]
    ds_write_b64 v2, v[4:5] offset:8192
    s_mov_b32 s36, 0
    buffer_load_dwordx4 v[8:11], v1, s[16:19], s36 offen nt
    buffer_load_dwordx4 v[12:15], v1, s[12:15], s36 offen nt
    s_mov_b32 s36, 16384
    buffer_load_dwordx4 v[16:19], v1, s[16:19], s36 offen nt
    buffer_load_dwordx4 v[20:23], v1, s[12:15], s36 offen nt
    s_mov_b32 s36, 32768
    buffer_load_dwordx4 v[24:27], v1, s[16:19], s36 offen nt
    buffer_load_dwordx4 v[28:31], v1, s[12:15], s36 offen nt
    s_mov_b32 s36, 49152
    buffer_load_dwordx4 v[32:35], v1, s[16:19], s36 offen nt
    buffer_load_dwordx4 v[36:39], v1, s[12:15], s36 offen nt
    s_add_u32 s24, s10, s34
    s_addc_u32 s25, s11, 0
    s_mov_b32 s26, 261120
    s_mov_b32 s27, 0x00020000
    s_add_u32 s28, s10, 88080384
    s_addc_u32 s29, s11, 0
    s_mov_b32 s30, 4096000
    s_mov_b32 s31, 0x00020000
    s_mov_b32 s40, 6710887
    s_mov_b32 s41, 67109
    s_mov_b32 s42, -640
    s_mov_b32 s44, 268435456
    s_mov_b32 s45, 0x05040100
    s_mov_b32 s46, 0x05040302
    v_mov_b32 v3, 1
    v_lshrrev_b32 v4, 6, v0
    s_nop 0
    v_readfirstlane_b32 s47, v4
    s_waitcnt lgkmcnt(0)
    s_barrier
    s_mov_b32 s36, 65536
    buffer_load_dwordx4 v[40:43], v1, s[16:19], s36 offen nt
    buffer_load_dwordx4 v[44:47], v1, s[12:15], s36 offen nt
    s_waitcnt vmcnt(8)
    v_mul_hi_u32 v108, v8, s40
    v_mul_hi_u32 v109, v9, s40
    v_mul_hi_u32 v110, v10, s40
    v_mul_hi_u32 v111, v11, s40
    v_mul_hi_u32 v112, v12, s41
    v_mul_hi_u32 v113, v13, s41
    v_mul_hi_u32 v114, v14, s41
    v_mul_hi_u32 v115, v15, s41
    v_mad_i32_i24 v116, v108, s42, v8
    v_mad_i32_i24 v117, v109, s42, v9
    v_mad_i32_i24 v118, v110, s42, v10
    v_mad_i32_i24 v119, v111, s42, v11
    v_lshl_add_u32 v120, v12, 1, s44
    v_lshl_add_u32 v121, v13, 1, s44
    v_lshl_add_u32 v122, v14, 1, s44
    v_lshl_add_u32 v123, v15, 1, s44
    v_lshl_add_u32 v108, v112, 9, v108
    v_lshl_add_u32 v109, v113, 9, v109
    v_lshl_add_u32 v110, v114, 9, v110
    v_lshl_add_u32 v111, v115, 9, v111
    v_lshl_add_u32 v8, v116, 22, v120
    v_lshl_add_u32 v10, v117, 22, v121
    v_lshl_add_u32 v12, v118, 22, v122
    v_lshl_add_u32 v14, v119, 22, v123
    v_lshlrev_b32 v9, 2, v108
    v_lshlrev_b32 v11, 2, v109
    v_lshlrev_b32 v13, 2, v110
    v_lshlrev_b32 v15, 2, v111
    ds_add_u32 v9, v3
    ds_add_u32 v11, v3
    ds_add_u32 v13, v3
    ds_add_u32 v15, v3
    s_mov_b32 s36, 81920
    buffer_load_dwordx4 v[48:51], v1, s[16:19], s36 offen nt
    buffer_load_dwordx4 v[52:55], v1, s[12:15], s36 offen nt
    s_waitcnt vmcnt(8)
    v_mul_hi_u32 v108, v16, s40
    v_mul_hi_u32 v109, v17, s40
    v_mul_hi_u32 v110, v18, s40
    v_mul_hi_u32 v111, v19, s40
    v_mul_hi_u32 v112, v20, s41
    v_mul_hi_u32 v113, v21, s41
    v_mul_hi_u32 v114, v22, s41
    v_mul_hi_u32 v115, v23, s41
    v_mad_i32_i24 v116, v108, s42, v16
    v_mad_i32_i24 v117, v109, s42, v17
    v_mad_i32_i24 v118, v110, s42, v18
    v_mad_i32_i24 v119, v111, s42, v19
    v_lshl_add_u32 v120, v20, 1, s44
    v_lshl_add_u32 v121, v21, 1, s44
    v_lshl_add_u32 v122, v22, 1, s44
    v_lshl_add_u32 v123, v23, 1, s44
    v_lshl_add_u32 v108, v112, 9, v108
    v_lshl_add_u32 v109, v113, 9, v109
    v_lshl_add_u32 v110, v114, 9, v110
    v_lshl_add_u32 v111, v115, 9, v111
    v_lshl_add_u32 v16, v116, 22, v120
    v_lshl_add_u32 v18, v117, 22, v121
    v_lshl_add_u32 v20, v118, 22, v122
    v_lshl_add_u32 v22, v119, 22, v123
    v_lshlrev_b32 v17, 2, v108
    v_lshlrev_b32 v19, 2, v109
    v_lshlrev_b32 v21, 2, v110
    v_lshlrev_b32 v23, 2, v111
    ds_add_u32 v17, v3
    ds_add_u32 v19, v3
    ds_add_u32 v21, v3
    ds_add_u32 v23, v3
    s_mov_b32 s36, 98304
    buffer_load_dwordx4 v[56:59], v1, s[16:19], s36 offen nt
    buffer_load_dwordx4 v[60:63], v1, s[12:15], s36 offen nt
    s_waitcnt vmcnt(8)
    v_mul_hi_u32 v108, v24, s40
    v_mul_hi_u32 v109, v25, s40
    v_mul_hi_u32 v110, v26, s40
    v_mul_hi_u32 v111, v27, s40
    v_mul_hi_u32 v112, v28, s41
    v_mul_hi_u32 v113, v29, s41
    v_mul_hi_u32 v114, v30, s41
    v_mul_hi_u32 v115, v31, s41
    v_mad_i32_i24 v116, v108, s42, v24
    v_mad_i32_i24 v117, v109, s42, v25
    v_mad_i32_i24 v118, v110, s42, v26
    v_mad_i32_i24 v119, v111, s42, v27
    v_lshl_add_u32 v120, v28, 1, s44
    v_lshl_add_u32 v121, v29, 1, s44
    v_lshl_add_u32 v122, v30, 1, s44
    v_lshl_add_u32 v123, v31, 1, s44
    v_lshl_add_u32 v108, v112, 9, v108
    v_lshl_add_u32 v109, v113, 9, v109
    v_lshl_add_u32 v110, v114, 9, v110
    v_lshl_add_u32 v111, v115, 9, v111
    v_lshl_add_u32 v24, v116, 22, v120
    v_lshl_add_u32 v26, v117, 22, v121
    v_lshl_add_u32 v28, v118, 22, v122
    v_lshl_add_u32 v30, v119, 22, v123
    v_lshlrev_b32 v25, 2, v108
    v_lshlrev_b32 v27, 2, v109
    v_lshlrev_b32 v29, 2, v110
    v_lshlrev_b32 v31, 2, v111
    ds_add_u32 v25, v3
    ds_add_u32 v27, v3
    ds_add_u32 v29, v3
    ds_add_u32 v31, v3
    s_mov_b32 s36, 114688
    buffer_load_dwordx4 v[64:67], v1, s[16:19], s36 offen nt
    buffer_load_dwordx4 v[68:71], v1, s[12:15], s36 offen nt
    s_waitcnt vmcnt(8)
    v_mul_hi_u32 v108, v32, s40
    v_mul_hi_u32 v109, v33, s40
    v_mul_hi_u32 v110, v34, s40
    v_mul_hi_u32 v111, v35, s40
    v_mul_hi_u32 v112, v36, s41
    v_mul_hi_u32 v113, v37, s41
    v_mul_hi_u32 v114, v38, s41
    v_mul_hi_u32 v115, v39, s41
    v_mad_i32_i24 v116, v108, s42, v32
    v_mad_i32_i24 v117, v109, s42, v33
    v_mad_i32_i24 v118, v110, s42, v34
    v_mad_i32_i24 v119, v111, s42, v35
    v_lshl_add_u32 v120, v36, 1, s44
    v_lshl_add_u32 v121, v37, 1, s44
    v_lshl_add_u32 v122, v38, 1, s44
    v_lshl_add_u32 v123, v39, 1, s44
    v_lshl_add_u32 v108, v112, 9, v108
    v_lshl_add_u32 v109, v113, 9, v109
    v_lshl_add_u32 v110, v114, 9, v110
    v_lshl_add_u32 v111, v115, 9, v111
    v_lshl_add_u32 v32, v116, 22, v120
    v_lshl_add_u32 v34, v117, 22, v121
    v_lshl_add_u32 v36, v118, 22, v122
    v_lshl_add_u32 v38, v119, 22, v123
    v_lshlrev_b32 v33, 2, v108
    v_lshlrev_b32 v35, 2, v109
    v_lshlrev_b32 v37, 2, v110
    v_lshlrev_b32 v39, 2, v111
    ds_add_u32 v33, v3
    ds_add_u32 v35, v3
    ds_add_u32 v37, v3
    ds_add_u32 v39, v3
    s_mov_b32 s36, 131072
    buffer_load_dwordx4 v[72:75], v1, s[16:19], s36 offen nt
    buffer_load_dwordx4 v[76:79], v1, s[12:15], s36 offen nt
    s_waitcnt vmcnt(8)
    v_mul_hi_u32 v108, v40, s40
    v_mul_hi_u32 v109, v41, s40
    v_mul_hi_u32 v110, v42, s40
    v_mul_hi_u32 v111, v43, s40
    v_mul_hi_u32 v112, v44, s41
    v_mul_hi_u32 v113, v45, s41
    v_mul_hi_u32 v114, v46, s41
    v_mul_hi_u32 v115, v47, s41
    v_mad_i32_i24 v116, v108, s42, v40
    v_mad_i32_i24 v117, v109, s42, v41
    v_mad_i32_i24 v118, v110, s42, v42
    v_mad_i32_i24 v119, v111, s42, v43
    v_lshl_add_u32 v120, v44, 1, s44
    v_lshl_add_u32 v121, v45, 1, s44
    v_lshl_add_u32 v122, v46, 1, s44
    v_lshl_add_u32 v123, v47, 1, s44
    v_lshl_add_u32 v108, v112, 9, v108
    v_lshl_add_u32 v109, v113, 9, v109
    v_lshl_add_u32 v110, v114, 9, v110
    v_lshl_add_u32 v111, v115, 9, v111
    v_lshl_add_u32 v40, v116, 22, v120
    v_lshl_add_u32 v42, v117, 22, v121
    v_lshl_add_u32 v44, v118, 22, v122
    v_lshl_add_u32 v46, v119, 22, v123
    v_lshlrev_b32 v41, 2, v108
    v_lshlrev_b32 v43, 2, v109
    v_lshlrev_b32 v45, 2, v110
    v_lshlrev_b32 v47, 2, v111
    ds_add_u32 v41, v3
    ds_add_u32 v43, v3
    ds_add_u32 v45, v3
    ds_add_u32 v47, v3
    s_mov_b32 s36, 147456
    buffer_load_dwordx4 v[80:83], v1, s[16:19], s36 offen nt
    buffer_load_dwordx4 v[84:87], v1, s[12:15], s36 offen nt
    s_mov_b32 s37, 0
    buffer_load_dwordx2 v[88:89], v2, s[20:23], s37 offen nt
    s_mov_b32 s37, 8192
    buffer_load_dwordx2 v[90:91], v2, s[20:23], s37 offen nt
    s_mov_b32 s37, 16384
    buffer_load_dwordx2 v[92:93], v2, s[20:23], s37 offen nt
    s_mov_b32 s37, 24576
    buffer_load_dwordx2 v[94:95], v2, s[20:23], s37 offen nt
    s_mov_b32 s37, 32768
    buffer_load_dwordx2 v[96:97], v2, s[20:23], s37 offen nt
    s_mov_b32 s37, 40960
    buffer_load_dwordx2 v[98:99], v2, s[20:23], s37 offen nt
    s_mov_b32 s37, 49152
    buffer_load_dwordx2 v[100:101], v2, s[20:23], s37 offen nt
    s_mov_b32 s37, 57344
    buffer_load_dwordx2 v[102:103], v2, s[20:23], s37 offen nt
    s_mov_b32 s37, 65536
    buffer_load_dwordx2 v[104:105], v2, s[20:23], s37 offen nt
    s_mov_b32 s37, 73728
    buffer_load_dwordx2 v[106:107], v2, s[20:23], s37 offen nt
    s_waitcnt vmcnt(18)
    v_mul_hi_u32 v108, v48, s40
    v_mul_hi_u32 v109, v49, s40
    v_mul_hi_u32 v110, v50, s40
    v_mul_hi_u32 v111, v51, s40
    v_mul_hi_u32 v112, v52, s41
    v_mul_hi_u32 v113, v53, s41
    v_mul_hi_u32 v114, v54, s41
    v_mul_hi_u32 v115, v55, s41
    v_mad_i32_i24 v116, v108, s42, v48
    v_mad_i32_i24 v117, v109, s42, v49
    v_mad_i32_i24 v118, v110, s42, v50
    v_mad_i32_i24 v119, v111, s42, v51
    v_lshl_add_u32 v120, v52, 1, s44
    v_lshl_add_u32 v121, v53, 1, s44
    v_lshl_add_u32 v122, v54, 1, s44
    v_lshl_add_u32 v123, v55, 1, s44
    v_lshl_add_u32 v108, v112, 9, v108
    v_lshl_add_u32 v109, v113, 9, v109
    v_lshl_add_u32 v110, v114, 9, v110
    v_lshl_add_u32 v111, v115, 9, v111
    v_lshl_add_u32 v48, v116, 22, v120
    v_lshl_add_u32 v50, v117, 22, v121
    v_lshl_add_u32 v52, v118, 22, v122
    v_lshl_add_u32 v54, v119, 22, v123
    v_lshlrev_b32 v49, 2, v108
    v_lshlrev_b32 v51, 2, v109
    v_lshlrev_b32 v53, 2, v110
    v_lshlrev_b32 v55, 2, v111
    ds_add_u32 v49, v3
    ds_add_u32 v51, v3
    ds_add_u32 v53, v3
    ds_add_u32 v55, v3
    s_waitcnt vmcnt(16)
    v_mul_hi_u32 v108, v56, s40
    v_mul_hi_u32 v109, v57, s40
    v_mul_hi_u32 v110, v58, s40
    v_mul_hi_u32 v111, v59, s40
    v_mul_hi_u32 v112, v60, s41
    v_mul_hi_u32 v113, v61, s41
    v_mul_hi_u32 v114, v62, s41
    v_mul_hi_u32 v115, v63, s41
    v_mad_i32_i24 v116, v108, s42, v56
    v_mad_i32_i24 v117, v109, s42, v57
    v_mad_i32_i24 v118, v110, s42, v58
    v_mad_i32_i24 v119, v111, s42, v59
    v_lshl_add_u32 v120, v60, 1, s44
    v_lshl_add_u32 v121, v61, 1, s44
    v_lshl_add_u32 v122, v62, 1, s44
    v_lshl_add_u32 v123, v63, 1, s44
    v_lshl_add_u32 v108, v112, 9, v108
    v_lshl_add_u32 v109, v113, 9, v109
    v_lshl_add_u32 v110, v114, 9, v110
    v_lshl_add_u32 v111, v115, 9, v111
    v_lshl_add_u32 v56, v116, 22, v120
    v_lshl_add_u32 v58, v117, 22, v121
    v_lshl_add_u32 v60, v118, 22, v122
    v_lshl_add_u32 v62, v119, 22, v123
    v_lshlrev_b32 v57, 2, v108
    v_lshlrev_b32 v59, 2, v109
    v_lshlrev_b32 v61, 2, v110
    v_lshlrev_b32 v63, 2, v111
    ds_add_u32 v57, v3
    ds_add_u32 v59, v3
    ds_add_u32 v61, v3
    ds_add_u32 v63, v3
    s_waitcnt vmcnt(14)
    v_mul_hi_u32 v108, v64, s40
    v_mul_hi_u32 v109, v65, s40
    v_mul_hi_u32 v110, v66, s40
    v_mul_hi_u32 v111, v67, s40
    v_mul_hi_u32 v112, v68, s41
    v_mul_hi_u32 v113, v69, s41
    v_mul_hi_u32 v114, v70, s41
    v_mul_hi_u32 v115, v71, s41
    v_mad_i32_i24 v116, v108, s42, v64
    v_mad_i32_i24 v117, v109, s42, v65
    v_mad_i32_i24 v118, v110, s42, v66
    v_mad_i32_i24 v119, v111, s42, v67
    v_lshl_add_u32 v120, v68, 1, s44
    v_lshl_add_u32 v121, v69, 1, s44
    v_lshl_add_u32 v122, v70, 1, s44
    v_lshl_add_u32 v123, v71, 1, s44
    v_lshl_add_u32 v108, v112, 9, v108
    v_lshl_add_u32 v109, v113, 9, v109
    v_lshl_add_u32 v110, v114, 9, v110
    v_lshl_add_u32 v111, v115, 9, v111
    v_lshl_add_u32 v64, v116, 22, v120
    v_lshl_add_u32 v66, v117, 22, v121
    v_lshl_add_u32 v68, v118, 22, v122
    v_lshl_add_u32 v70, v119, 22, v123
    v_lshlrev_b32 v65, 2, v108
    v_lshlrev_b32 v67, 2, v109
    v_lshlrev_b32 v69, 2, v110
    v_lshlrev_b32 v71, 2, v111
    ds_add_u32 v65, v3
    ds_add_u32 v67, v3
    ds_add_u32 v69, v3
    ds_add_u32 v71, v3
    s_waitcnt vmcnt(12)
    v_mul_hi_u32 v108, v72, s40
    v_mul_hi_u32 v109, v73, s40
    v_mul_hi_u32 v110, v74, s40
    v_mul_hi_u32 v111, v75, s40
    v_mul_hi_u32 v112, v76, s41
    v_mul_hi_u32 v113, v77, s41
    v_mul_hi_u32 v114, v78, s41
    v_mul_hi_u32 v115, v79, s41
    v_mad_i32_i24 v116, v108, s42, v72
    v_mad_i32_i24 v117, v109, s42, v73
    v_mad_i32_i24 v118, v110, s42, v74
    v_mad_i32_i24 v119, v111, s42, v75
    v_lshl_add_u32 v120, v76, 1, s44
    v_lshl_add_u32 v121, v77, 1, s44
    v_lshl_add_u32 v122, v78, 1, s44
    v_lshl_add_u32 v123, v79, 1, s44
    v_lshl_add_u32 v108, v112, 9, v108
    v_lshl_add_u32 v109, v113, 9, v109
    v_lshl_add_u32 v110, v114, 9, v110
    v_lshl_add_u32 v111, v115, 9, v111
    v_lshl_add_u32 v72, v116, 22, v120
    v_lshl_add_u32 v74, v117, 22, v121
    v_lshl_add_u32 v76, v118, 22, v122
    v_lshl_add_u32 v78, v119, 22, v123
    v_lshlrev_b32 v73, 2, v108
    v_lshlrev_b32 v75, 2, v109
    v_lshlrev_b32 v77, 2, v110
    v_lshlrev_b32 v79, 2, v111
    ds_add_u32 v73, v3
    ds_add_u32 v75, v3
    ds_add_u32 v77, v3
    ds_add_u32 v79, v3
    s_waitcnt vmcnt(10)
    v_mul_hi_u32 v108, v80, s40
    v_mul_hi_u32 v109, v81, s40
    v_mul_hi_u32 v110, v82, s40
    v_mul_hi_u32 v111, v83, s40
    v_mul_hi_u32 v112, v84, s41
    v_mul_hi_u32 v113, v85, s41
    v_mul_hi_u32 v114, v86, s41
    v_mul_hi_u32 v115, v87, s41
    v_mad_i32_i24 v116, v108, s42, v80
    v_mad_i32_i24 v117, v109, s42, v81
    v_mad_i32_i24 v118, v110, s42, v82
    v_mad_i32_i24 v119, v111, s42, v83
    v_lshl_add_u32 v120, v84, 1, s44
    v_lshl_add_u32 v121, v85, 1, s44
    v_lshl_add_u32 v122, v86, 1, s44
    v_lshl_add_u32 v123, v87, 1, s44
    v_lshl_add_u32 v108, v112, 9, v108
    v_lshl_add_u32 v109, v113, 9, v109
    v_lshl_add_u32 v110, v114, 9, v110
    v_lshl_add_u32 v111, v115, 9, v111
    v_lshl_add_u32 v80, v116, 22, v120
    v_lshl_add_u32 v82, v117, 22, v121
    v_lshl_add_u32 v84, v118, 22, v122
    v_lshl_add_u32 v86, v119, 22, v123
    v_lshlrev_b32 v81, 2, v108
    v_lshlrev_b32 v83, 2, v109
    v_lshlrev_b32 v85, 2, v110
    v_lshlrev_b32 v87, 2, v111
    ds_add_u32 v81, v3
    ds_add_u32 v83, v3
    ds_add_u32 v85, v3
    ds_add_u32 v87, v3
    s_waitcnt lgkmcnt(0)
    s_barrier
    s_cmp_ge_u32 s47, 8
    s_cbranch_scc1 L_p1_noscan1
    v_mul_u32_u24 v1, 20, v0
    ds_read2_b32 v[108:109], v1 offset0:0 offset1:1
    ds_read2_b32 v[110:111], v1 offset0:2 offset1:3
    ds_read_b32 v2, v1 offset:16
    v_and_b32 v126, 63, v0
    v_lshlrev_b32 v126, 2, v126
    s_waitcnt lgkmcnt(0)
    v_add_u32 v112, 1, v108
    v_add_u32 v113, 1, v109
    v_add_u32 v114, 1, v110
    v_add_u32 v115, 1, v111
    v_add_u32 v4, 1, v2
    v_and_b32 v112, -2, v112
    v_and_b32 v113, -2, v113
    v_and_b32 v114, -2, v114
    v_and_b32 v115, -2, v115
    v_and_b32 v4, -2, v4
    v_add_u32 v116, v112, v113
    v_add_u32 v117, v114, v115
    v_add_u32 v116, v116, v117
    v_add_u32 v116, v116, v4
    v_mov_b32 v117, v116
    s_nop 1
    v_add_u32_dpp v117, v117, v117 row_shr:1 row_mask:0xf bank_mask:0xf bound_ctrl:0
    s_nop 1
    v_add_u32_dpp v117, v117, v117 row_shr:2 row_mask:0xf bank_mask:0xf bound_ctrl:0
    s_nop 1
    v_add_u32_dpp v117, v117, v117 row_shr:4 row_mask:0xf bank_mask:0xf bound_ctrl:0
    s_nop 1
    v_add_u32_dpp v117, v117, v117 row_shr:8 row_mask:0xf bank_mask:0xf bound_ctrl:0
    s_nop 1
    v_add_u32_dpp v117, v117, v117 row_bcast:15 row_mask:0xa bank_mask:0xf
    s_nop 1
    v_add_u32_dpp v117, v117, v117 row_bcast:31 row_mask:0xc bank_mask:0xf
    s_nop 1
    v_readlane_b32 s48, v117, 63
    s_add_u32 s49, s47, 1
    s_lshl_b32 s50, -1, s49
    s_and_b32 s50, s50, 0x1ff
    v_mov_b32 v118, s48
    s_mov_b32 exec_lo, s50
    s_mov_b32 exec_hi, 0
    ds_add_u32 v126, v118 offset:10240
    s_mov_b64 exec, -1
L_p1_noscan1:
    s_waitcnt lgkmcnt(0)
    s_barrier
    v_mov_b32 v127, 0
    ds_read_b32 v5, v127 offset:10272
    s_cmp_ge_u32 s47, 8
    s_cbranch_scc1 L_p1_noscan2a
    s_lshl_b32 s49, s47, 2
    v_mov_b32 v119, s49
    ds_read_b32 v119, v119 offset:10240
    s_waitcnt lgkmcnt(0)
    v_readfirstlane_b32 s49, v5
    v_add_u32 v117, v117, v119
    v_sub_u32 v120, v117, v116
    v_add_u32 v121, v120, v112
    v_add_u32 v122, v121, v113
    v_add_u32 v123, v122, v114
    v_add_u32 v124, v123, v115
    v_add_u32 v125, v124, v4
    ds_write2_b32 v1, v120, v121 offset0:0 offset1:1
    ds_write2_b32 v1, v122, v123 offset0:2 offset1:3
    ds_write_b32 v1, v124 offset:16
    v_lshl_or_b32 v112, v121, 16, v120
    v_lshl_or_b32 v113, v122, 16, v121
    v_lshl_or_b32 v114, v123, 16, v122
    v_lshl_or_b32 v115, v124, 16, v123
    v_lshl_or_b32 v116, v125, 16, v124
    v_add_u32 v1, 141568, v1
    ds_write2_b32 v1, v112, v113 offset0:0 offset1:1
    ds_write2_b32 v1, v114, v115 offset0:2 offset1:3
    ds_write_b32 v1, v116 offset:16
    v_mov_b32 v127, 0xffff0000
    v_add_u32 v112, v120, v108
    v_and_b32 v108, 1, v108
    v_add_u32 v113, v121, v109
    v_and_b32 v109, 1, v109
    v_add_u32 v114, v122, v110
    v_and_b32 v110, 1, v110
    v_add_u32 v115, v123, v111
    v_and_b32 v111, 1, v111
    v_add_u32 v116, v124, v2
    v_and_b32 v2, 1, v2
    v_lshlrev_b32 v112, 16, v112
    v_cmp_eq_u32 vcc, 1, v108
    s_nop 1
    v_cndmask_b32 v4, v127, v112, vcc
    v_lshlrev_b32 v113, 16, v113
    v_cmp_eq_u32 vcc, 1, v109
    s_nop 1
    v_cndmask_b32 v5, v127, v113, vcc
    v_lshlrev_b32 v114, 16, v114
    v_cmp_eq_u32 vcc, 1, v110
    s_nop 1
    v_cndmask_b32 v6, v127, v114, vcc
    v_lshlrev_b32 v115, 16, v115
    v_cmp_eq_u32 vcc, 1, v111
    s_nop 1
    v_cndmask_b32 v7, v127, v115, vcc
    v_lshlrev_b32 v116, 16, v116
    v_cmp_eq_u32 vcc, 1, v2
    s_nop 1
    v_cndmask_b32 v1, v127, v116, vcc
    s_branch L_p1_noscan2
L_p1_noscan2a:
    s_waitcnt lgkmcnt(0)
    v_readfirstlane_b32 s49, v5
    s_nop 1
    v_mov_b32 v4, 0xffff0000
    v_mov_b32 v5, 0xffff0000
    v_mov_b32 v6, 0xffff0000
    v_mov_b32 v7, 0xffff0000
    v_mov_b32 v1, 0xffff0000
L_p1_noscan2:
    v_mov_b32 v2, 0
    s_waitcnt lgkmcnt(0)
    s_mul_i32 s51, s49, 6
    s_min_u32 s26, s51, 98304
    s_barrier
    s_cmp_ge_u32 s47, 8
    s_cbranch_scc1 L_p1_notab
    v_lshlrev_b32 v127, 2, v0
    v_add_u32 v127, 141568, v127
    ds_read_b32 v112, v127 offset:0
    ds_read_b32 v113, v127 offset:2048
    ds_read_b32 v114, v127 offset:4096
    ds_read_b32 v115, v127 offset:6144
    ds_read_b32 v116, v127 offset:8192
    v_lshlrev_b32 v117, 13, v0
    s_lshl_b32 s49, s2, 5
    s_waitcnt lgkmcnt(0)
    buffer_store_dwordx4 v[112:115], v117, s[28:31], s49 offen
    buffer_store_dword v116, v117, s[28:31], s49 offen offset:16
    s_nop 1
L_p1_notab:
    ds_add_rtn_u32 v108, v9, v3
    ds_add_rtn_u32 v109, v11, v3
    ds_add_rtn_u32 v110, v13, v3
    ds_add_rtn_u32 v111, v15, v3
    ds_add_rtn_u32 v112, v17, v3
    ds_add_rtn_u32 v113, v19, v3
    ds_add_rtn_u32 v114, v21, v3
    ds_add_rtn_u32 v115, v23, v3
    ds_add_rtn_u32 v116, v25, v3
    ds_add_rtn_u32 v117, v27, v3
    ds_add_rtn_u32 v118, v29, v3
    ds_add_rtn_u32 v119, v31, v3
    ds_add_rtn_u32 v120, v33, v3
    ds_add_rtn_u32 v121, v35, v3
    ds_add_rtn_u32 v122, v37, v3
    ds_add_rtn_u32 v123, v39, v3
    ds_add_rtn_u32 v124, v41, v3
    ds_add_rtn_u32 v125, v43, v3
    ds_add_rtn_u32 v126, v45, v3
    ds_add_rtn_u32 v127, v47, v3
    s_waitcnt vmcnt(0)
    s_waitcnt lgkmcnt(15)
    v_perm_b32 v9, v108, v88, s45
    v_perm_b32 v11, v109, v88, s46
    v_perm_b32 v13, v110, v89, s45
    v_perm_b32 v15, v111, v89, s46
    s_waitcnt lgkmcnt(12)
    v_perm_b32 v17, v112, v90, s45
    v_perm_b32 v19, v113, v90, s46
    v_perm_b32 v21, v114, v91, s45
    v_perm_b32 v23, v115, v91, s46
    s_waitcnt lgkmcnt(8)
    v_perm_b32 v25, v116, v92, s45
    v_perm_b32 v27, v117, v92, s46
    v_perm_b32 v29, v118, v93, s45
    v_perm_b32 v31, v119, v93, s46
    s_waitcnt lgkmcnt(4)
    v_perm_b32 v33, v120, v94, s45
    v_perm_b32 v35, v121, v94, s46
    v_perm_b32 v37, v122, v95, s45
    v_perm_b32 v39, v123, v95, s46
    s_waitcnt lgkmcnt(0)
    v_perm_b32 v41, v124, v96, s45
    v_perm_b32 v43, v125, v96, s46
    v_perm_b32 v45, v126, v97, s45
    v_perm_b32 v47, v127, v97, s46
    ds_add_rtn_u32 v108, v49, v3
    ds_add_rtn_u32 v109, v51, v3
    ds_add_rtn_u32 v110, v53, v3
    ds_add_rtn_u32 v111, v55, v3
    ds_add_rtn_u32 v112, v57, v3
    ds_add_rtn_u32 v113, v59, v3
    ds_add_rtn_u32 v114, v61, v3
    ds_add_rtn_u32 v115, v63, v3
    ds_add_rtn_u32 v116, v65, v3
    ds_add_rtn_u32 v117, v67, v3
    ds_add_rtn_u32 v118, v69, v3
    ds_add_rtn_u32 v119, v71, v3
    ds_add_rtn_u32 v120, v73, v3
    ds_add_rtn_u32 v121, v75, v3
    ds_add_rtn_u32 v122, v77, v3
    ds_add_rtn_u32 v123, v79, v3
    ds_add_rtn_u32 v124, v81, v3
    ds_add_rtn_u32 v125, v83, v3
    ds_add_rtn_u32 v126, v85, v3
    ds_add_rtn_u32 v127, v87, v3
    s_waitcnt lgkmcnt(15)
    v_perm_b32 v49, v108, v98, s45
    v_perm_b32 v51, v109, v98, s46
    v_perm_b32 v53, v110, v99, s45
    v_perm_b32 v55, v111, v99, s46
    s_waitcnt lgkmcnt(12)
    v_perm_b32 v57, v112, v100, s45
    v_perm_b32 v59, v113, v100, s46
    v_perm_b32 v61, v114, v101, s45
    v_perm_b32 v63, v115, v101, s46
    s_waitcnt lgkmcnt(8)
    v_perm_b32 v65, v116, v102, s45
    v_perm_b32 v67, v117, v102, s46
    v_perm_b32 v69, v118, v103, s45
    v_perm_b32 v71, v119, v103, s46
    s_waitcnt lgkmcnt(4)
    v_perm_b32 v73, v120, v104, s45
    v_perm_b32 v75, v121, v104, s46
    v_perm_b32 v77, v122, v105, s45
    v_perm_b32 v79, v123, v105, s46
    s_waitcnt lgkmcnt(0)
    v_perm_b32 v81, v124, v106, s45
    v_perm_b32 v83, v125, v106, s46
    v_perm_b32 v85, v126, v107, s45
    v_perm_b32 v87, v127, v107, s46
    v_mul_u32_u24 v107, 12, v0
    s_mov_b32 s50, 0x40000000
    v_lshlrev_b32 v104, 4, v0
    v_add_u32 v105, 65536, v104
    v_mov_b32 v88, 0
    v_mov_b32 v89, v4
    v_mov_b32 v90, 0
    v_mov_b32 v91, v5
    v_mov_b32 v92, 0
    v_mov_b32 v93, v6
    v_mov_b32 v94, 0
    v_mov_b32 v95, v7
    v_mov_b32 v100, 0
    v_mov_b32 v101, v1
    s_mov_b32 s53, 0xc0000000
    s_mov_b32 s52, 0x2900
    v_cmpx_gt_u32 vcc, s50, v9
    v_mad_u32_u16 v96, v9, 8, s52 op_sel:[1,0,0,0]
    ds_write_b64 v96, v[8:9]
    s_mov_b64 exec, -1
    v_cmpx_gt_u32 vcc, s50, v11
    v_mad_u32_u16 v97, v11, 8, s52 op_sel:[1,0,0,0]
    ds_write_b64 v97, v[10:11]
    s_mov_b64 exec, -1
    v_cmpx_gt_u32 vcc, s50, v13
    v_mad_u32_u16 v98, v13, 8, s52 op_sel:[1,0,0,0]
    ds_write_b64 v98, v[12:13]
    s_mov_b64 exec, -1
    v_cmpx_gt_u32 vcc, s50, v15
    v_mad_u32_u16 v99, v15, 8, s52 op_sel:[1,0,0,0]
    ds_write_b64 v99, v[14:15]
    s_mov_b64 exec, -1
    v_cmpx_gt_u32 vcc, s50, v17
    v_mad_u32_u16 v96, v17, 8, s52 op_sel:[1,0,0,0]
    ds_write_b64 v96, v[16:17]
    s_mov_b64 exec, -1
    v_cmpx_gt_u32 vcc, s50, v19
    v_mad_u32_u16 v97, v19, 8, s52 op_sel:[1,0,0,0]
    ds_write_b64 v97, v[18:19]
    s_mov_b64 exec, -1
    v_cmpx_gt_u32 vcc, s50, v21
    v_mad_u32_u16 v98, v21, 8, s52 op_sel:[1,0,0,0]
    ds_write_b64 v98, v[20:21]
    s_mov_b64 exec, -1
    v_cmpx_gt_u32 vcc, s50, v23
    v_mad_u32_u16 v99, v23, 8, s52 op_sel:[1,0,0,0]
    ds_write_b64 v99, v[22:23]
    s_mov_b64 exec, -1
    v_cmpx_gt_u32 vcc, s50, v25
    v_mad_u32_u16 v96, v25, 8, s52 op_sel:[1,0,0,0]
    ds_write_b64 v96, v[24:25]
    s_mov_b64 exec, -1
    v_cmpx_gt_u32 vcc, s50, v27
    v_mad_u32_u16 v97, v27, 8, s52 op_sel:[1,0,0,0]
    ds_write_b64 v97, v[26:27]
    s_mov_b64 exec, -1
    v_cmpx_gt_u32 vcc, s50, v29
    v_mad_u32_u16 v98, v29, 8, s52 op_sel:[1,0,0,0]
    ds_write_b64 v98, v[28:29]
    s_mov_b64 exec, -1
    v_cmpx_gt_u32 vcc, s50, v31
    v_mad_u32_u16 v99, v31, 8, s52 op_sel:[1,0,0,0]
    ds_write_b64 v99, v[30:31]
    s_mov_b64 exec, -1
    v_cmpx_gt_u32 vcc, s50, v33
    v_mad_u32_u16 v96, v33, 8, s52 op_sel:[1,0,0,0]
    ds_write_b64 v96, v[32:33]
    s_mov_b64 exec, -1
    v_cmpx_gt_u32 vcc, s50, v35
    v_mad_u32_u16 v97, v35, 8, s52 op_sel:[1,0,0,0]
    ds_write_b64 v97, v[34:35]
    s_mov_b64 exec, -1
    v_cmpx_gt_u32 vcc, s50, v37
    v_mad_u32_u16 v98, v37, 8, s52 op_sel:[1,0,0,0]
    ds_write_b64 v98, v[36:37]
    s_mov_b64 exec, -1
    v_cmpx_gt_u32 vcc, s50, v39
    v_mad_u32_u16 v99, v39, 8, s52 op_sel:[1,0,0,0]
    ds_write_b64 v99, v[38:39]
    s_mov_b64 exec, -1
    v_cmpx_gt_u32 vcc, s50, v41
    v_mad_u32_u16 v96, v41, 8, s52 op_sel:[1,0,0,0]
    ds_write_b64 v96, v[40:41]
    s_mov_b64 exec, -1
    v_cmpx_gt_u32 vcc, s50, v43
    v_mad_u32_u16 v97, v43, 8, s52 op_sel:[1,0,0,0]
    ds_write_b64 v97, v[42:43]
    s_mov_b64 exec, -1
    v_cmpx_gt_u32 vcc, s50, v45
    v_mad_u32_u16 v98, v45, 8, s52 op_sel:[1,0,0,0]
    ds_write_b64 v98, v[44:45]
    s_mov_b64 exec, -1
    v_cmpx_gt_u32 vcc, s50, v47
    v_mad_u32_u16 v99, v47, 8, s52 op_sel:[1,0,0,0]
    ds_write_b64 v99, v[46:47]
    s_mov_b64 exec, -1
    v_cmpx_gt_u32 vcc, s50, v49
    v_mad_u32_u16 v96, v49, 8, s52 op_sel:[1,0,0,0]
    ds_write_b64 v96, v[48:49]
    s_mov_b64 exec, -1
    v_cmpx_gt_u32 vcc, s50, v51
    v_mad_u32_u16 v97, v51, 8, s52 op_sel:[1,0,0,0]
    ds_write_b64 v97, v[50:51]
    s_mov_b64 exec, -1
    v_cmpx_gt_u32 vcc, s50, v53
    v_mad_u32_u16 v98, v53, 8, s52 op_sel:[1,0,0,0]
    ds_write_b64 v98, v[52:53]
    s_mov_b64 exec, -1
    v_cmpx_gt_u32 vcc, s50, v55
    v_mad_u32_u16 v99, v55, 8, s52 op_sel:[1,0,0,0]
    ds_write_b64 v99, v[54:55]
    s_mov_b64 exec, -1
    v_cmpx_gt_u32 vcc, s50, v57
    v_mad_u32_u16 v96, v57, 8, s52 op_sel:[1,0,0,0]
    ds_write_b64 v96, v[56:57]
    s_mov_b64 exec, -1
    v_cmpx_gt_u32 vcc, s50, v59
    v_mad_u32_u16 v97, v59, 8, s52 op_sel:[1,0,0,0]
    ds_write_b64 v97, v[58:59]
    s_mov_b64 exec, -1
    v_cmpx_gt_u32 vcc, s50, v61
    v_mad_u32_u16 v98, v61, 8, s52 op_sel:[1,0,0,0]
    ds_write_b64 v98, v[60:61]
    s_mov_b64 exec, -1
    v_cmpx_gt_u32 vcc, s50, v63
    v_mad_u32_u16 v99, v63, 8, s52 op_sel:[1,0,0,0]
    ds_write_b64 v99, v[62:63]
    s_mov_b64 exec, -1
    v_cmpx_gt_u32 vcc, s50, v65
    v_mad_u32_u16 v96, v65, 8, s52 op_sel:[1,0,0,0]
    ds_write_b64 v96, v[64:65]
    s_mov_b64 exec, -1
    v_cmpx_gt_u32 vcc, s50, v67
    v_mad_u32_u16 v97, v67, 8, s52 op_sel:[1,0,0,0]
    ds_write_b64 v97, v[66:67]
    s_mov_b64 exec, -1
    v_cmpx_gt_u32 vcc, s50, v69
    v_mad_u32_u16 v98, v69, 8, s52 op_sel:[1,0,0,0]
    ds_write_b64 v98, v[68:69]
    s_mov_b64 exec, -1
    v_cmpx_gt_u32 vcc, s50, v71
    v_mad_u32_u16 v99, v71, 8, s52 op_sel:[1,0,0,0]
    ds_write_b64 v99, v[70:71]
    s_mov_b64 exec, -1
    v_cmpx_gt_u32 vcc, s50, v73
    v_mad_u32_u16 v96, v73, 8, s52 op_sel:[1,0,0,0]
    ds_write_b64 v96, v[72:73]
    s_mov_b64 exec, -1
    v_cmpx_gt_u32 vcc, s50, v75
    v_mad_u32_u16 v97, v75, 8, s52 op_sel:[1,0,0,0]
    ds_write_b64 v97, v[74:75]
    s_mov_b64 exec, -1
    v_cmpx_gt_u32 vcc, s50, v77
    v_mad_u32_u16 v98, v77, 8, s52 op_sel:[1,0,0,0]
    ds_write_b64 v98, v[76:77]
    s_mov_b64 exec, -1
    v_cmpx_gt_u32 vcc, s50, v79
    v_mad_u32_u16 v99, v79, 8, s52 op_sel:[1,0,0,0]
    ds_write_b64 v99, v[78:79]
    s_mov_b64 exec, -1
    v_cmpx_gt_u32 vcc, s50, v81
    v_mad_u32_u16 v96, v81, 8, s52 op_sel:[1,0,0,0]
    ds_write_b64 v96, v[80:81]
    s_mov_b64 exec, -1
    v_cmpx_gt_u32 vcc, s50, v83
    v_mad_u32_u16 v97, v83, 8, s52 op_sel:[1,0,0,0]
    ds_write_b64 v97, v[82:83]
    s_mov_b64 exec, -1
    v_cmpx_gt_u32 vcc, s50, v85
    v_mad_u32_u16 v98, v85, 8, s52 op_sel:[1,0,0,0]
    ds_write_b64 v98, v[84:85]
    s_mov_b64 exec, -1
    v_cmpx_gt_u32 vcc, s50, v87
    v_mad_u32_u16 v99, v87, 8, s52 op_sel:[1,0,0,0]
    ds_write_b64 v99, v[86:87]
    s_mov_b64 exec, -1
    v_cmpx_gt_u32 vcc, s50, v89
    v_mad_u32_u16 v96, v89, 8, s52 op_sel:[1,0,0,0]
    ds_write_b64 v96, v[88:89]
    s_mov_b64 exec, -1
    v_cmpx_gt_u32 vcc, s50, v91
    v_mad_u32_u16 v97, v91, 8, s52 op_sel:[1,0,0,0]
    ds_write_b64 v97, v[90:91]
    s_mov_b64 exec, -1
    v_cmpx_gt_u32 vcc, s50, v93
    v_mad_u32_u16 v98, v93, 8, s52 op_sel:[1,0,0,0]
    ds_write_b64 v98, v[92:93]
    s_mov_b64 exec, -1
    v_cmpx_gt_u32 vcc, s50, v95
    v_mad_u32_u16 v99, v95, 8, s52 op_sel:[1,0,0,0]
    ds_write_b64 v99, v[94:95]
    s_mov_b64 exec, -1
    v_cmpx_gt_u32 vcc, s50, v101
    v_mad_u32_u16 v96, v101, 8, s52 op_sel:[1,0,0,0]
    ds_write_b64 v96, v[100:101]
    s_mov_b64 exec, -1
    s_waitcnt lgkmcnt(0)
    s_barrier
    ds_read_b128 v[108:111], v104 offset:10496
    ds_read_b128 v[112:115], v104 offset:26880
    ds_read_b128 v[116:119], v104 offset:43264
    ds_read_b128 v[120:123], v104 offset:59648
    s_waitcnt lgkmcnt(3)
    v_perm_b32 v109, v111, v109, s45
    s_mov_b32 s49, 0
    buffer_store_dwordx3 v[108:110], v107, s[24:27], s49 offen
    s_waitcnt lgkmcnt(2)
    v_perm_b32 v113, v115, v113, s45
    s_mov_b32 s49, 12288
    buffer_store_dwordx3 v[112:114], v107, s[24:27], s49 offen
    s_waitcnt lgkmcnt(1)
    v_perm_b32 v117, v119, v117, s45
    s_mov_b32 s49, 24576
    buffer_store_dwordx3 v[116:118], v107, s[24:27], s49 offen
    s_waitcnt lgkmcnt(0)
    v_perm_b32 v121, v123, v121, s45
    s_mov_b32 s49, 36864
    buffer_store_dwordx3 v[120:122], v107, s[24:27], s49 offen
    s_nop 1
    ds_read_b128 v[108:111], v105 offset:10496
    ds_read_b128 v[112:115], v105 offset:26880
    ds_read_b128 v[116:119], v105 offset:43264
    ds_read_b128 v[120:123], v105 offset:59648
    s_waitcnt lgkmcnt(3)
    v_perm_b32 v109, v111, v109, s45
    s_mov_b32 s49, 49152
    buffer_store_dwordx3 v[108:110], v107, s[24:27], s49 offen
    s_waitcnt lgkmcnt(2)
    v_perm_b32 v113, v115, v113, s45
    s_mov_b32 s49, 61440
    buffer_store_dwordx3 v[112:114], v107, s[24:27], s49 offen
    s_waitcnt lgkmcnt(1)
    v_perm_b32 v117, v119, v117, s45
    s_mov_b32 s49, 73728
    buffer_store_dwordx3 v[116:118], v107, s[24:27], s49 offen
    s_waitcnt lgkmcnt(0)
    v_perm_b32 v121, v123, v121, s45
    s_mov_b32 s49, 86016
    buffer_store_dwordx3 v[120:122], v107, s[24:27], s49 offen
    s_barrier
    s_min_u32 s26, s51, 196608
    s_nop 1
    s_mov_b32 s52, 0xfffe2900
    v_cmpx_le_i32 vcc, s50, v9
    v_mad_u32_u16 v96, v9, 8, s52 op_sel:[1,0,0,0]
    ds_write_b64 v96, v[8:9]
    s_mov_b64 exec, -1
    v_cmpx_le_i32 vcc, s50, v11
    v_mad_u32_u16 v97, v11, 8, s52 op_sel:[1,0,0,0]
    ds_write_b64 v97, v[10:11]
    s_mov_b64 exec, -1
    v_cmpx_le_i32 vcc, s50, v13
    v_mad_u32_u16 v98, v13, 8, s52 op_sel:[1,0,0,0]
    ds_write_b64 v98, v[12:13]
    s_mov_b64 exec, -1
    v_cmpx_le_i32 vcc, s50, v15
    v_mad_u32_u16 v99, v15, 8, s52 op_sel:[1,0,0,0]
    ds_write_b64 v99, v[14:15]
    s_mov_b64 exec, -1
    v_cmpx_le_i32 vcc, s50, v17
    v_mad_u32_u16 v96, v17, 8, s52 op_sel:[1,0,0,0]
    ds_write_b64 v96, v[16:17]
    s_mov_b64 exec, -1
    v_cmpx_le_i32 vcc, s50, v19
    v_mad_u32_u16 v97, v19, 8, s52 op_sel:[1,0,0,0]
    ds_write_b64 v97, v[18:19]
    s_mov_b64 exec, -1
    v_cmpx_le_i32 vcc, s50, v21
    v_mad_u32_u16 v98, v21, 8, s52 op_sel:[1,0,0,0]
    ds_write_b64 v98, v[20:21]
    s_mov_b64 exec, -1
    v_cmpx_le_i32 vcc, s50, v23
    v_mad_u32_u16 v99, v23, 8, s52 op_sel:[1,0,0,0]
    ds_write_b64 v99, v[22:23]
    s_mov_b64 exec, -1
    v_cmpx_le_i32 vcc, s50, v25
    v_mad_u32_u16 v96, v25, 8, s52 op_sel:[1,0,0,0]
    ds_write_b64 v96, v[24:25]
    s_mov_b64 exec, -1
    v_cmpx_le_i32 vcc, s50, v27
    v_mad_u32_u16 v97, v27, 8, s52 op_sel:[1,0,0,0]
    ds_write_b64 v97, v[26:27]
    s_mov_b64 exec, -1
    v_cmpx_le_i32 vcc, s50, v29
    v_mad_u32_u16 v98, v29, 8, s52 op_sel:[1,0,0,0]
    ds_write_b64 v98, v[28:29]
    s_mov_b64 exec, -1
    v_cmpx_le_i32 vcc, s50, v31
    v_mad_u32_u16 v99, v31, 8, s52 op_sel:[1,0,0,0]
    ds_write_b64 v99, v[30:31]
    s_mov_b64 exec, -1
    v_cmpx_le_i32 vcc, s50, v33
    v_mad_u32_u16 v96, v33, 8, s52 op_sel:[1,0,0,0]
    ds_write_b64 v96, v[32:33]
    s_mov_b64 exec, -1
    v_cmpx_le_i32 vcc, s50, v35
    v_mad_u32_u16 v97, v35, 8, s52 op_sel:[1,0,0,0]
    ds_write_b64 v97, v[34:35]
    s_mov_b64 exec, -1
    v_cmpx_le_i32 vcc, s50, v37
    v_mad_u32_u16 v98, v37, 8, s52 op_sel:[1,0,0,0]
    ds_write_b64 v98, v[36:37]
    s_mov_b64 exec, -1
    v_cmpx_le_i32 vcc, s50, v39
    v_mad_u32_u16 v99, v39, 8, s52 op_sel:[1,0,0,0]
    ds_write_b64 v99, v[38:39]
    s_mov_b64 exec, -1
    v_cmpx_le_i32 vcc, s50, v41
    v_mad_u32_u16 v96, v41, 8, s52 op_sel:[1,0,0,0]
    ds_write_b64 v96, v[40:41]
    s_mov_b64 exec, -1
    v_cmpx_le_i32 vcc, s50, v43
    v_mad_u32_u16 v97, v43, 8, s52 op_sel:[1,0,0,0]
    ds_write_b64 v97, v[42:43]
    s_mov_b64 exec, -1
    v_cmpx_le_i32 vcc, s50, v45
    v_mad_u32_u16 v98, v45, 8, s52 op_sel:[1,0,0,0]
    ds_write_b64 v98, v[44:45]
    s_mov_b64 exec, -1
    v_cmpx_le_i32 vcc, s50, v47
    v_mad_u32_u16 v99, v47, 8, s52 op_sel:[1,0,0,0]
    ds_write_b64 v99, v[46:47]
    s_mov_b64 exec, -1
    v_cmpx_le_i32 vcc, s50, v49
    v_mad_u32_u16 v96, v49, 8, s52 op_sel:[1,0,0,0]
    ds_write_b64 v96, v[48:49]
    s_mov_b64 exec, -1
    v_cmpx_le_i32 vcc, s50, v51
    v_mad_u32_u16 v97, v51, 8, s52 op_sel:[1,0,0,0]
    ds_write_b64 v97, v[50:51]
    s_mov_b64 exec, -1
    v_cmpx_le_i32 vcc, s50, v53
    v_mad_u32_u16 v98, v53, 8, s52 op_sel:[1,0,0,0]
    ds_write_b64 v98, v[52:53]
    s_mov_b64 exec, -1
    v_cmpx_le_i32 vcc, s50, v55
    v_mad_u32_u16 v99, v55, 8, s52 op_sel:[1,0,0,0]
    ds_write_b64 v99, v[54:55]
    s_mov_b64 exec, -1
    v_cmpx_le_i32 vcc, s50, v57
    v_mad_u32_u16 v96, v57, 8, s52 op_sel:[1,0,0,0]
    ds_write_b64 v96, v[56:57]
    s_mov_b64 exec, -1
    v_cmpx_le_i32 vcc, s50, v59
    v_mad_u32_u16 v97, v59, 8, s52 op_sel:[1,0,0,0]
    ds_write_b64 v97, v[58:59]
    s_mov_b64 exec, -1
    v_cmpx_le_i32 vcc, s50, v61
    v_mad_u32_u16 v98, v61, 8, s52 op_sel:[1,0,0,0]
    ds_write_b64 v98, v[60:61]
    s_mov_b64 exec, -1
    v_cmpx_le_i32 vcc, s50, v63
    v_mad_u32_u16 v99, v63, 8, s52 op_sel:[1,0,0,0]
    ds_write_b64 v99, v[62:63]
    s_mov_b64 exec, -1
    v_cmpx_le_i32 vcc, s50, v65
    v_mad_u32_u16 v96, v65, 8, s52 op_sel:[1,0,0,0]
    ds_write_b64 v96, v[64:65]
    s_mov_b64 exec, -1
    v_cmpx_le_i32 vcc, s50, v67
    v_mad_u32_u16 v97, v67, 8, s52 op_sel:[1,0,0,0]
    ds_write_b64 v97, v[66:67]
    s_mov_b64 exec, -1
    v_cmpx_le_i32 vcc, s50, v69
    v_mad_u32_u16 v98, v69, 8, s52 op_sel:[1,0,0,0]
    ds_write_b64 v98, v[68:69]
    s_mov_b64 exec, -1
    v_cmpx_le_i32 vcc, s50, v71
    v_mad_u32_u16 v99, v71, 8, s52 op_sel:[1,0,0,0]
    ds_write_b64 v99, v[70:71]
    s_mov_b64 exec, -1
    v_cmpx_le_i32 vcc, s50, v73
    v_mad_u32_u16 v96, v73, 8, s52 op_sel:[1,0,0,0]
    ds_write_b64 v96, v[72:73]
    s_mov_b64 exec, -1
    v_cmpx_le_i32 vcc, s50, v75
    v_mad_u32_u16 v97, v75, 8, s52 op_sel:[1,0,0,0]
    ds_write_b64 v97, v[74:75]
    s_mov_b64 exec, -1
    v_cmpx_le_i32 vcc, s50, v77
    v_mad_u32_u16 v98, v77, 8, s52 op_sel:[1,0,0,0]
    ds_write_b64 v98, v[76:77]
    s_mov_b64 exec, -1
    v_cmpx_le_i32 vcc, s50, v79
    v_mad_u32_u16 v99, v79, 8, s52 op_sel:[1,0,0,0]
    ds_write_b64 v99, v[78:79]
    s_mov_b64 exec, -1
    v_cmpx_le_i32 vcc, s50, v81
    v_mad_u32_u16 v96, v81, 8, s52 op_sel:[1,0,0,0]
    ds_write_b64 v96, v[80:81]
    s_mov_b64 exec, -1
    v_cmpx_le_i32 vcc, s50, v83
    v_mad_u32_u16 v97, v83, 8, s52 op_sel:[1,0,0,0]
    ds_write_b64 v97, v[82:83]
    s_mov_b64 exec, -1
    v_cmpx_le_i32 vcc, s50, v85
    v_mad_u32_u16 v98, v85, 8, s52 op_sel:[1,0,0,0]
    ds_write_b64 v98, v[84:85]
    s_mov_b64 exec, -1
    v_cmpx_le_i32 vcc, s50, v87
    v_mad_u32_u16 v99, v87, 8, s52 op_sel:[1,0,0,0]
    ds_write_b64 v99, v[86:87]
    s_mov_b64 exec, -1
    v_cmpx_le_i32 vcc, s50, v89
    v_mad_u32_u16 v96, v89, 8, s52 op_sel:[1,0,0,0]
    ds_write_b64 v96, v[88:89]
    s_mov_b64 exec, -1
    v_cmpx_le_i32 vcc, s50, v91
    v_mad_u32_u16 v97, v91, 8, s52 op_sel:[1,0,0,0]
    ds_write_b64 v97, v[90:91]
    s_mov_b64 exec, -1
    v_cmpx_le_i32 vcc, s50, v93
    v_mad_u32_u16 v98, v93, 8, s52 op_sel:[1,0,0,0]
    ds_write_b64 v98, v[92:93]
    s_mov_b64 exec, -1
    v_cmpx_le_i32 vcc, s50, v95
    v_mad_u32_u16 v99, v95, 8, s52 op_sel:[1,0,0,0]
    ds_write_b64 v99, v[94:95]
    s_mov_b64 exec, -1
    v_cmpx_le_i32 vcc, s50, v101
    v_mad_u32_u16 v96, v101, 8, s52 op_sel:[1,0,0,0]
    ds_write_b64 v96, v[100:101]
    s_mov_b64 exec, -1
    s_waitcnt lgkmcnt(0)
    s_barrier
    ds_read_b128 v[108:111], v104 offset:10496
    ds_read_b128 v[112:115], v104 offset:26880
    ds_read_b128 v[116:119], v104 offset:43264
    ds_read_b128 v[120:123], v104 offset:59648
    s_waitcnt lgkmcnt(3)
    v_perm_b32 v109, v111, v109, s45
    s_mov_b32 s49, 98304
    buffer_store_dwordx3 v[108:110], v107, s[24:27], s49 offen
    s_waitcnt lgkmcnt(2)
    v_perm_b32 v113, v115, v113, s45
    s_mov_b32 s49, 110592
    buffer_store_dwordx3 v[112:114], v107, s[24:27], s49 offen
    s_waitcnt lgkmcnt(1)
    v_perm_b32 v117, v119, v117, s45
    s_mov_b32 s49, 122880
    buffer_store_dwordx3 v[116:118], v107, s[24:27], s49 offen
    s_waitcnt lgkmcnt(0)
    v_perm_b32 v121, v123, v121, s45
    s_mov_b32 s49, 135168
    buffer_store_dwordx3 v[120:122], v107, s[24:27], s49 offen
    s_nop 1
    ds_read_b128 v[108:111], v105 offset:10496
    ds_read_b128 v[112:115], v105 offset:26880
    ds_read_b128 v[116:119], v105 offset:43264
    ds_read_b128 v[120:123], v105 offset:59648
    s_waitcnt lgkmcnt(3)
    v_perm_b32 v109, v111, v109, s45
    s_mov_b32 s49, 147456
    buffer_store_dwordx3 v[108:110], v107, s[24:27], s49 offen
    s_waitcnt lgkmcnt(2)
    v_perm_b32 v113, v115, v113, s45
    s_mov_b32 s49, 159744
    buffer_store_dwordx3 v[112:114], v107, s[24:27], s49 offen
    s_waitcnt lgkmcnt(1)
    v_perm_b32 v117, v119, v117, s45
    s_mov_b32 s49, 172032
    buffer_store_dwordx3 v[116:118], v107, s[24:27], s49 offen
    s_waitcnt lgkmcnt(0)
    v_perm_b32 v121, v123, v121, s45
    s_mov_b32 s49, 184320
    buffer_store_dwordx3 v[120:122], v107, s[24:27], s49 offen
    s_barrier
    s_min_u32 s26, s51, 294912
    s_nop 1
    s_mov_b32 s52, 0xfffc2900
    v_cmpx_gt_i32 vcc, s53, v9
    v_mad_u32_u16 v96, v9, 8, s52 op_sel:[1,0,0,0]
    ds_write_b64 v96, v[8:9]
    s_mov_b64 exec, -1
    v_cmpx_gt_i32 vcc, s53, v11
    v_mad_u32_u16 v97, v11, 8, s52 op_sel:[1,0,0,0]
    ds_write_b64 v97, v[10:11]
    s_mov_b64 exec, -1
    v_cmpx_gt_i32 vcc, s53, v13
    v_mad_u32_u16 v98, v13, 8, s52 op_sel:[1,0,0,0]
    ds_write_b64 v98, v[12:13]
    s_mov_b64 exec, -1
    v_cmpx_gt_i32 vcc, s53, v15
    v_mad_u32_u16 v99, v15, 8, s52 op_sel:[1,0,0,0]
    ds_write_b64 v99, v[14:15]
    s_mov_b64 exec, -1
    v_cmpx_gt_i32 vcc, s53, v17
    v_mad_u32_u16 v96, v17, 8, s52 op_sel:[1,0,0,0]
    ds_write_b64 v96, v[16:17]
    s_mov_b64 exec, -1
    v_cmpx_gt_i32 vcc, s53, v19
    v_mad_u32_u16 v97, v19, 8, s52 op_sel:[1,0,0,0]
    ds_write_b64 v97, v[18:19]
    s_mov_b64 exec, -1
    v_cmpx_gt_i32 vcc, s53, v21
    v_mad_u32_u16 v98, v21, 8, s52 op_sel:[1,0,0,0]
    ds_write_b64 v98, v[20:21]
    s_mov_b64 exec, -1
    v_cmpx_gt_i32 vcc, s53, v23
    v_mad_u32_u16 v99, v23, 8, s52 op_sel:[1,0,0,0]
    ds_write_b64 v99, v[22:23]
    s_mov_b64 exec, -1
    v_cmpx_gt_i32 vcc, s53, v25
    v_mad_u32_u16 v96, v25, 8, s52 op_sel:[1,0,0,0]
    ds_write_b64 v96, v[24:25]
    s_mov_b64 exec, -1
    v_cmpx_gt_i32 vcc, s53, v27
    v_mad_u32_u16 v97, v27, 8, s52 op_sel:[1,0,0,0]
    ds_write_b64 v97, v[26:27]
    s_mov_b64 exec, -1
    v_cmpx_gt_i32 vcc, s53, v29
    v_mad_u32_u16 v98, v29, 8, s52 op_sel:[1,0,0,0]
    ds_write_b64 v98, v[28:29]
    s_mov_b64 exec, -1
    v_cmpx_gt_i32 vcc, s53, v31
    v_mad_u32_u16 v99, v31, 8, s52 op_sel:[1,0,0,0]
    ds_write_b64 v99, v[30:31]
    s_mov_b64 exec, -1
    v_cmpx_gt_i32 vcc, s53, v33
    v_mad_u32_u16 v96, v33, 8, s52 op_sel:[1,0,0,0]
    ds_write_b64 v96, v[32:33]
    s_mov_b64 exec, -1
    v_cmpx_gt_i32 vcc, s53, v35
    v_mad_u32_u16 v97, v35, 8, s52 op_sel:[1,0,0,0]
    ds_write_b64 v97, v[34:35]
    s_mov_b64 exec, -1
    v_cmpx_gt_i32 vcc, s53, v37
    v_mad_u32_u16 v98, v37, 8, s52 op_sel:[1,0,0,0]
    ds_write_b64 v98, v[36:37]
    s_mov_b64 exec, -1
    v_cmpx_gt_i32 vcc, s53, v39
    v_mad_u32_u16 v99, v39, 8, s52 op_sel:[1,0,0,0]
    ds_write_b64 v99, v[38:39]
    s_mov_b64 exec, -1
    v_cmpx_gt_i32 vcc, s53, v41
    v_mad_u32_u16 v96, v41, 8, s52 op_sel:[1,0,0,0]
    ds_write_b64 v96, v[40:41]
    s_mov_b64 exec, -1
    v_cmpx_gt_i32 vcc, s53, v43
    v_mad_u32_u16 v97, v43, 8, s52 op_sel:[1,0,0,0]
    ds_write_b64 v97, v[42:43]
    s_mov_b64 exec, -1
    v_cmpx_gt_i32 vcc, s53, v45
    v_mad_u32_u16 v98, v45, 8, s52 op_sel:[1,0,0,0]
    ds_write_b64 v98, v[44:45]
    s_mov_b64 exec, -1
    v_cmpx_gt_i32 vcc, s53, v47
    v_mad_u32_u16 v99, v47, 8, s52 op_sel:[1,0,0,0]
    ds_write_b64 v99, v[46:47]
    s_mov_b64 exec, -1
    v_cmpx_gt_i32 vcc, s53, v49
    v_mad_u32_u16 v96, v49, 8, s52 op_sel:[1,0,0,0]
    ds_write_b64 v96, v[48:49]
    s_mov_b64 exec, -1
    v_cmpx_gt_i32 vcc, s53, v51
    v_mad_u32_u16 v97, v51, 8, s52 op_sel:[1,0,0,0]
    ds_write_b64 v97, v[50:51]
    s_mov_b64 exec, -1
    v_cmpx_gt_i32 vcc, s53, v53
    v_mad_u32_u16 v98, v53, 8, s52 op_sel:[1,0,0,0]
    ds_write_b64 v98, v[52:53]
    s_mov_b64 exec, -1
    v_cmpx_gt_i32 vcc, s53, v55
    v_mad_u32_u16 v99, v55, 8, s52 op_sel:[1,0,0,0]
    ds_write_b64 v99, v[54:55]
    s_mov_b64 exec, -1
    v_cmpx_gt_i32 vcc, s53, v57
    v_mad_u32_u16 v96, v57, 8, s52 op_sel:[1,0,0,0]
    ds_write_b64 v96, v[56:57]
    s_mov_b64 exec, -1
    v_cmpx_gt_i32 vcc, s53, v59
    v_mad_u32_u16 v97, v59, 8, s52 op_sel:[1,0,0,0]
    ds_write_b64 v97, v[58:59]
    s_mov_b64 exec, -1
    v_cmpx_gt_i32 vcc, s53, v61
    v_mad_u32_u16 v98, v61, 8, s52 op_sel:[1,0,0,0]
    ds_write_b64 v98, v[60:61]
    s_mov_b64 exec, -1
    v_cmpx_gt_i32 vcc, s53, v63
    v_mad_u32_u16 v99, v63, 8, s52 op_sel:[1,0,0,0]
    ds_write_b64 v99, v[62:63]
    s_mov_b64 exec, -1
    v_cmpx_gt_i32 vcc, s53, v65
    v_mad_u32_u16 v96, v65, 8, s52 op_sel:[1,0,0,0]
    ds_write_b64 v96, v[64:65]
    s_mov_b64 exec, -1
    v_cmpx_gt_i32 vcc, s53, v67
    v_mad_u32_u16 v97, v67, 8, s52 op_sel:[1,0,0,0]
    ds_write_b64 v97, v[66:67]
    s_mov_b64 exec, -1
    v_cmpx_gt_i32 vcc, s53, v69
    v_mad_u32_u16 v98, v69, 8, s52 op_sel:[1,0,0,0]
    ds_write_b64 v98, v[68:69]
    s_mov_b64 exec, -1
    v_cmpx_gt_i32 vcc, s53, v71
    v_mad_u32_u16 v99, v71, 8, s52 op_sel:[1,0,0,0]
    ds_write_b64 v99, v[70:71]
    s_mov_b64 exec, -1
    v_cmpx_gt_i32 vcc, s53, v73
    v_mad_u32_u16 v96, v73, 8, s52 op_sel:[1,0,0,0]
    ds_write_b64 v96, v[72:73]
    s_mov_b64 exec, -1
    v_cmpx_gt_i32 vcc, s53, v75
    v_mad_u32_u16 v97, v75, 8, s52 op_sel:[1,0,0,0]
    ds_write_b64 v97, v[74:75]
    s_mov_b64 exec, -1
    v_cmpx_gt_i32 vcc, s53, v77
    v_mad_u32_u16 v98, v77, 8, s52 op_sel:[1,0,0,0]
    ds_write_b64 v98, v[76:77]
    s_mov_b64 exec, -1
    v_cmpx_gt_i32 vcc, s53, v79
    v_mad_u32_u16 v99, v79, 8, s52 op_sel:[1,0,0,0]
    ds_write_b64 v99, v[78:79]
    s_mov_b64 exec, -1
    v_cmpx_gt_i32 vcc, s53, v81
    v_mad_u32_u16 v96, v81, 8, s52 op_sel:[1,0,0,0]
    ds_write_b64 v96, v[80:81]
    s_mov_b64 exec, -1
    v_cmpx_gt_i32 vcc, s53, v83
    v_mad_u32_u16 v97, v83, 8, s52 op_sel:[1,0,0,0]
    ds_write_b64 v97, v[82:83]
    s_mov_b64 exec, -1
    v_cmpx_gt_i32 vcc, s53, v85
    v_mad_u32_u16 v98, v85, 8, s52 op_sel:[1,0,0,0]
    ds_write_b64 v98, v[84:85]
    s_mov_b64 exec, -1
    v_cmpx_gt_i32 vcc, s53, v87
    v_mad_u32_u16 v99, v87, 8, s52 op_sel:[1,0,0,0]
    ds_write_b64 v99, v[86:87]
    s_mov_b64 exec, -1
    v_cmpx_gt_i32 vcc, s53, v89
    v_mad_u32_u16 v96, v89, 8, s52 op_sel:[1,0,0,0]
    ds_write_b64 v96, v[88:89]
    s_mov_b64 exec, -1
    v_cmpx_gt_i32 vcc, s53, v91
    v_mad_u32_u16 v97, v91, 8, s52 op_sel:[1,0,0,0]
    ds_write_b64 v97, v[90:91]
    s_mov_b64 exec, -1
    v_cmpx_gt_i32 vcc, s53, v93
    v_mad_u32_u16 v98, v93, 8, s52 op_sel:[1,0,0,0]
    ds_write_b64 v98, v[92:93]
    s_mov_b64 exec, -1
    v_cmpx_gt_i32 vcc, s53, v95
    v_mad_u32_u16 v99, v95, 8, s52 op_sel:[1,0,0,0]
    ds_write_b64 v99, v[94:95]
    s_mov_b64 exec, -1
    v_cmpx_gt_i32 vcc, s53, v101
    v_mad_u32_u16 v96, v101, 8, s52 op_sel:[1,0,0,0]
    ds_write_b64 v96, v[100:101]
    s_mov_b64 exec, -1
    s_waitcnt lgkmcnt(0)
    s_barrier
    ds_read_b128 v[108:111], v104 offset:10496
    ds_read_b128 v[112:115], v104 offset:26880
    ds_read_b128 v[116:119], v104 offset:43264
    ds_read_b128 v[120:123], v104 offset:59648
    s_waitcnt lgkmcnt(3)
    v_perm_b32 v109, v111, v109, s45
    s_mov_b32 s49, 196608
    buffer_store_dwordx3 v[108:110], v107, s[24:27], s49 offen
    s_waitcnt lgkmcnt(2)
    v_perm_b32 v113, v115, v113, s45
    s_mov_b32 s49, 208896
    buffer_store_dwordx3 v[112:114], v107, s[24:27], s49 offen
    s_waitcnt lgkmcnt(1)
    v_perm_b32 v117, v119, v117, s45
    s_mov_b32 s49, 221184
    buffer_store_dwordx3 v[116:118], v107, s[24:27], s49 offen
    s_waitcnt lgkmcnt(0)
    v_perm_b32 v121, v123, v121, s45
    s_mov_b32 s49, 233472
    buffer_store_dwordx3 v[120:122], v107, s[24:27], s49 offen
    s_nop 1
    ds_read_b128 v[108:111], v105 offset:10496
    ds_read_b128 v[112:115], v105 offset:26880
    s_waitcnt lgkmcnt(1)
    v_perm_b32 v109, v111, v109, s45
    s_mov_b32 s49, 245760
    buffer_store_dwordx3 v[108:110], v107, s[24:27], s49 offen
    s_waitcnt lgkmcnt(0)
    v_perm_b32 v113, v115, v113, s45
    s_mov_b32 s49, 258048
    buffer_store_dwordx3 v[112:114], v107, s[24:27], s49 offen
L_p1_end:
    s_endpgm
.globl consume_kernel
.p2align 8
.type consume_kernel,@function
consume_kernel:
    s_cmp_ge_u32 s2, 500
    s_cbranch_scc1 L_p2_end
    s_load_dwordx2 s[4:5], s[0:1], 0
    s_load_dwordx2 s[58:59], s[0:1], 104
    s_and_b32 s50, s2, 7
    s_lshr_b32 s51, s2, 3
    s_mul_i32 s56, s50, 63
    s_sub_i32 s50, s50, 4
    s_max_i32 s50, s50, 0
    s_sub_u32 s56, s56, s50
    s_add_u32 s56, s56, s51
    v_lshrrev_b32 v20, 6, v0
    v_and_b32 v21, 63, v0
    v_readfirstlane_b32 s12, v20
    v_and_b32 v22, 15, v21
    v_lshrrev_b32 v23, 4, v21
    s_waitcnt lgkmcnt(0)
    s_lshl_b32 s50, s56, 13
    s_add_u32 s50, s50, 88080384
    s_add_u32 s64, s58, s50
    s_addc_u32 s65, s59, 0
    s_mov_b32 s66, 8000
    s_mov_b32 s67, 0x00020000
    v_mov_b32 v33, 0x80000000
    s_mov_b32 s69, 0
    s_lshl_b32 s50, s12, 5
    v_add_u32 v24, s50, v21
    v_lshlrev_b32 v24, 5, v24
    v_cmp_gt_u32 vcc, 32, v21
    s_nop 1
    v_cndmask_b32 v24, v33, v24, vcc
    buffer_load_dwordx4 v[2:5], v24, s[64:67], 0 offen
    buffer_load_dword v9, v24, s[64:67], 0 offen offset:16
    s_or_b32 s5, s5, 1048576
    s_mov_b32 s6, 640000
    s_mov_b32 s7, 0x00020000
    s_mov_b32 s8, s58
    s_mov_b32 s9, s59
    s_mov_b32 s10, 65280000
    s_mov_b32 s11, 0x00020000
    v_and_b32 v26, 3, v21
    v_lshlrev_b32 v26, 3, v26
    v_lshl_add_u32 v26, v23, 5, v26
    v_add_u32 v1, 33280, v26
    v_lshrrev_b32 v25, 1, v21
    v_lshrrev_b32 v26, 3, v25
    v_and_b32 v27, 1, v26
    v_lshlrev_b32 v27, 2, v27
    v_add_u32 v27, v27, v25
    v_and_b32 v27, 7, v27
    v_lshl_add_u32 v27, v26, 3, v27
    v_lshlrev_b32 v27, 2, v27
    v_add_u32 v15, 33280, v27
    v_and_b32 v6, 1, v21
    v_lshrrev_b32 v25, 2, v22
    v_and_b32 v26, 1, v23
    v_lshlrev_b32 v26, 2, v26
    v_add_u32 v25, v25, v26
    v_lshl_add_u32 v25, v23, 3, v25
    v_and_b32 v26, 3, v21
    v_lshlrev_b32 v26, 3, v26
    v_lshl_add_u32 v25, v25, 5, v26
    s_lshl_b32 s49, s12, 12
    v_add_u32 v7, s49, v25
    v_xor_b32 v8, 128, v7
    s_mul_i32 s55, s12, 5
    s_add_u32 s55, s55, 4
    s_mul_i32 s46, s12, 3840
    v_lshlrev_b32 v25, 1, v22
    v_lshl_or_b32 v14, v25, 16, v25
    s_lshr_b32 s42, s2, 3
    s_mul_i32 s42, s42, 264
    s_mul_i32 s50, s12, 33
    s_add_u32 s42, s42, s50
    s_lshl_b32 s42, s42, 3
    s_mov_b32 s43, 0
    v_and_b32 v25, 31, v21
    v_lshlrev_b32 v25, 2, v25
    v_mov_b32 v26, -1
    ds_write_b32 v25, v26 offset:64000
    v_subrev_u32 v25, 4, v21
    v_mul_u32_u24 v26, 768, v25
    v_mov_b32 v10, 0x40000000
    v_cmp_gt_u32 vcc, 40, v25
    s_nop 1
    v_cndmask_b32 v10, v10, v26, vcc
    v_cmp_eq_u32 vcc, 56, v21
    s_nop 1
    v_mov_b32 v26, 0
    v_cndmask_b32 v10, v10, v26, vcc
    v_lshlrev_b32 v11, 2, v21
    ds_write_b32 v11, v10 offset:32768
    ds_write_b32 v11, v10 offset:33024
    v_mov_b32 v39, v10
    v_mov_b32 v68, 0
    v_mov_b32 v69, 0
    v_mov_b32 v70, 0
    v_mov_b32 v71, 0
    v_mov_b32 v72, 0
    v_mov_b32 v73, 0
    v_mov_b32 v74, 0
    v_mov_b32 v75, 0
    v_mov_b32 v76, 0
    v_mov_b32 v77, 0
    v_mov_b32 v78, 0
    v_mov_b32 v79, 0
    v_mov_b32 v80, 0
    v_mov_b32 v81, 0
    v_mov_b32 v82, 0
    v_mov_b32 v83, 0
    v_mov_b32 v84, 0
    v_mov_b32 v85, 0
    v_mov_b32 v86, 0
    v_mov_b32 v87, 0
    v_mov_b32 v88, 0
    v_mov_b32 v89, 0
    v_mov_b32 v90, 0
    v_mov_b32 v91, 0
    v_mov_b32 v92, 0
    v_mov_b32 v93, 0
    v_mov_b32 v94, 0
    v_mov_b32 v95, 0
    v_mov_b32 v96, 0
    v_mov_b32 v97, 0
    v_mov_b32 v98, 0
    v_mov_b32 v99, 0
    v_mov_b32 v100, 0
    v_mov_b32 v101, 0
    v_mov_b32 v102, 0
    v_mov_b32 v103, 0
    v_mov_b32 v104, 0
    v_mov_b32 v105, 0
    v_mov_b32 v106, 0
    v_mov_b32 v107, 0
    v_mov_b32 v108, 0
    v_mov_b32 v109, 0
    v_mov_b32 v110, 0
    v_mov_b32 v111, 0
    v_mov_b32 v112, 0
    v_mov_b32 v113, 0
    v_mov_b32 v114, 0
    v_mov_b32 v115, 0
    v_mov_b32 v116, 0
    v_mov_b32 v117, 0
    v_mov_b32 v118, 0
    v_mov_b32 v119, 0
    v_mov_b32 v120, 0
    v_mov_b32 v121, 0
    v_mov_b32 v122, 0
    v_mov_b32 v123, 0
    v_mov_b32 v124, 0
    v_mov_b32 v125, 0
    v_mov_b32 v126, 0
    v_mov_b32 v127, 0
    s_mov_b32 s52, 0xfc
    s_mov_b32 s53, 0xffffe
    s_mov_b32 s47, 0x001f001f
    s_mov_b32 s48, 0x07060302
    s_mov_b32 s54, 0
    s_mov_b32 s13, 0
    s_waitcnt vmcnt(0) lgkmcnt(0)
    s_barrier
L_p2_phase:
    s_mov_b32 s14, 0
    s_mov_b32 s15, 0
    s_mov_b32 s16, 0
L_p2_round:
    v_mbcnt_lo_u32_b32 v22, -1, 0
    v_mbcnt_hi_u32_b32 v22, -1, v22
    s_lshl_b32 s50, s12, 5
    v_lshrrev_b32 v32, 4, v22
    v_and_b32 v33, 15, v22
    v_add_u32 v34, s50, v32
    s_mov_b32 s51, 261120
    v_lshlrev_b32 v32, 2, v32
    v_mul_lo_u32 v34, v34, s51
    v_lshlrev_b32 v33, 1, v33
    v_mov_b32 v35, 4
    v_mov_b32 v30, v2
    s_cmp_eq_u32 s14, 0
    s_cbranch_scc1 L_p2_gated
    s_lshr_b32 s50, s15, 3
    s_and_b32 s51, s15, 7
    s_lshl_b32 s51, s51, 2
    s_lshl_b32 s51, 15, s51
    s_cmp_eq_u32 s50, s12
    s_cselect_b32 s60, s51, 0
    s_mov_b32 s61, 0
    v_cndmask_b32 v30, 0, v2, s[60:61]
L_p2_gated:
    v_sub_u32_sdwa v31, v30, v30 dst_sel:DWORD dst_unused:UNUSED_PAD src0_sel:WORD_1 src1_sel:WORD_0
    s_lshl_b32 s17, s16, 5
    s_cmp_eq_u32 s69, 0
    s_mov_b32 s69, 0
    s_cbranch_scc0 L_p2_bin
L_p2_wloop:
    s_mov_b32 s43, 0
    s_waitcnt vmcnt(0)
    ds_bpermute_b32 v12, v32, v30 offset:0
    ds_bpermute_b32 v13, v32, v30 offset:16
    ds_bpermute_b32 v16, v32, v30 offset:32
    ds_bpermute_b32 v17, v32, v30 offset:48
    ds_bpermute_b32 v18, v32, v30 offset:64
    ds_bpermute_b32 v19, v32, v30 offset:80
    ds_bpermute_b32 v20, v32, v30 offset:96
    ds_bpermute_b32 v21, v32, v30 offset:112
    v_add_u32 v22, s17, v33
    s_waitcnt lgkmcnt(0)
    v_add_u32_sdwa v36, v12, v22 dst_sel:DWORD dst_unused:UNUSED_PAD src0_sel:WORD_0 src1_sel:DWORD
    v_add_u32_sdwa v40, v13, v22 dst_sel:DWORD dst_unused:UNUSED_PAD src0_sel:WORD_0 src1_sel:DWORD
    v_add_u32_sdwa v44, v16, v22 dst_sel:DWORD dst_unused:UNUSED_PAD src0_sel:WORD_0 src1_sel:DWORD
    v_add_u32_sdwa v48, v17, v22 dst_sel:DWORD dst_unused:UNUSED_PAD src0_sel:WORD_0 src1_sel:DWORD
    v_add_u32_sdwa v52, v18, v22 dst_sel:DWORD dst_unused:UNUSED_PAD src0_sel:WORD_0 src1_sel:DWORD
    v_add_u32_sdwa v56, v19, v22 dst_sel:DWORD dst_unused:UNUSED_PAD src0_sel:WORD_0 src1_sel:DWORD
    v_add_u32_sdwa v60, v20, v22 dst_sel:DWORD dst_unused:UNUSED_PAD src0_sel:WORD_0 src1_sel:DWORD
    v_add_u32_sdwa v64, v21, v22 dst_sel:DWORD dst_unused:UNUSED_PAD src0_sel:WORD_0 src1_sel:DWORD
    v_cmp_lt_u32_sdwa s[20:21], v36, v12 src0_sel:DWORD src1_sel:WORD_1
    v_cmp_lt_u32_sdwa s[22:23], v40, v13 src0_sel:DWORD src1_sel:WORD_1
    v_cmp_lt_u32_sdwa s[24:25], v44, v16 src0_sel:DWORD src1_sel:WORD_1
    v_cmp_lt_u32_sdwa s[26:27], v48, v17 src0_sel:DWORD src1_sel:WORD_1
    v_cmp_lt_u32_sdwa s[28:29], v52, v18 src0_sel:DWORD src1_sel:WORD_1
    v_cmp_lt_u32_sdwa s[30:31], v56, v19 src0_sel:DWORD src1_sel:WORD_1
    v_cmp_lt_u32_sdwa s[32:33], v60, v20 src0_sel:DWORD src1_sel:WORD_1
    v_cmp_lt_u32_sdwa s[34:35], v64, v21 src0_sel:DWORD src1_sel:WORD_1
    v_mad_u32_u24 v36, v36, 6, v34
    v_mad_u32_u24 v40, v40, 6, v34
    v_mad_u32_u24 v44, v44, 6, v34
    v_mad_u32_u24 v48, v48, 6, v34
    v_mad_u32_u24 v52, v52, 6, v34
    v_mad_u32_u24 v56, v56, 6, v34
    v_mad_u32_u24 v60, v60, 6, v34
    v_mad_u32_u24 v64, v64, 6, v34
    s_mov_b32 s62, 0
    s_mov_b64 exec, s[20:21]
    buffer_load_dwordx3 v[36:38], v36, s[8:11], s62 offen
    s_mov_b32 s62, 1044480
    s_mov_b64 exec, s[22:23]
    buffer_load_dwordx3 v[40:42], v40, s[8:11], s62 offen
    s_mov_b32 s62, 2088960
    s_mov_b64 exec, s[24:25]
    buffer_load_dwordx3 v[44:46], v44, s[8:11], s62 offen
    s_mov_b32 s62, 3133440
    s_mov_b64 exec, s[26:27]
    buffer_load_dwordx3 v[48:50], v48, s[8:11], s62 offen
    s_mov_b32 s62, 4177920
    s_mov_b64 exec, s[28:29]
    buffer_load_dwordx3 v[52:54], v52, s[8:11], s62 offen
    s_mov_b32 s62, 5222400
    s_mov_b64 exec, s[30:31]
    buffer_load_dwordx3 v[56:58], v56, s[8:11], s62 offen
    s_mov_b32 s62, 6266880
    s_mov_b64 exec, s[32:33]
    buffer_load_dwordx3 v[60:62], v60, s[8:11], s62 offen
    s_mov_b32 s62, 7311360
    s_mov_b64 exec, s[34:35]
    buffer_load_dwordx3 v[64:66], v64, s[8:11], s62 offen
    s_mov_b64 exec, -1
L_p2_bin:
    s_cmp_eq_u32 s54, 0
    s_cbranch_scc0 L_p2_par1
    s_waitcnt vmcnt(4)
    s_mov_b64 exec, s[20:21]
    v_and_b32_sdwa v12, s52, v36 dst_sel:DWORD dst_unused:UNUSED_PAD src0_sel:DWORD src1_sel:BYTE_3
    ds_add_rtn_u32 v12, v12, v35 offset:32768
    v_and_b32_sdwa v13, s52, v38 dst_sel:DWORD dst_unused:UNUSED_PAD src0_sel:DWORD src1_sel:BYTE_3
    ds_add_rtn_u32 v13, v13, v35 offset:32768
    s_mov_b64 exec, s[22:23]
    v_and_b32_sdwa v16, s52, v40 dst_sel:DWORD dst_unused:UNUSED_PAD src0_sel:DWORD src1_sel:BYTE_3
    ds_add_rtn_u32 v16, v16, v35 offset:32768
    v_and_b32_sdwa v17, s52, v42 dst_sel:DWORD dst_unused:UNUSED_PAD src0_sel:DWORD src1_sel:BYTE_3
    ds_add_rtn_u32 v17, v17, v35 offset:32768
    s_mov_b64 exec, s[24:25]
    v_and_b32_sdwa v18, s52, v44 dst_sel:DWORD dst_unused:UNUSED_PAD src0_sel:DWORD src1_sel:BYTE_3
    ds_add_rtn_u32 v18, v18, v35 offset:32768
    v_and_b32_sdwa v19, s52, v46 dst_sel:DWORD dst_unused:UNUSED_PAD src0_sel:DWORD src1_sel:BYTE_3
    ds_add_rtn_u32 v19, v19, v35 offset:32768
    s_mov_b64 exec, s[26:27]
    v_and_b32_sdwa v20, s52, v48 dst_sel:DWORD dst_unused:UNUSED_PAD src0_sel:DWORD src1_sel:BYTE_3
    ds_add_rtn_u32 v20, v20, v35 offset:32768
    v_and_b32_sdwa v21, s52, v50 dst_sel:DWORD dst_unused:UNUSED_PAD src0_sel:DWORD src1_sel:BYTE_3
    ds_add_rtn_u32 v21, v21, v35 offset:32768
    s_mov_b64 exec, -1
    s_waitcnt lgkmcnt(0)
    s_mov_b64 exec, s[20:21]
    ds_write_b32 v12, v36 offset:33280
    v_lshrrev_b32 v22, 1, v12
    ds_write_b16 v22, v37 offset:64128
    ds_write_b32 v13, v38 offset:33280
    v_lshrrev_b32 v23, 1, v13
    ds_write_b16_d16_hi v23, v37 offset:64128
    s_mov_b64 exec, s[22:23]
    ds_write_b32 v16, v40 offset:33280
    v_lshrrev_b32 v24, 1, v16
    ds_write_b16 v24, v41 offset:64128
    ds_write_b32 v17, v42 offset:33280
    v_lshrrev_b32 v25, 1, v17
    ds_write_b16_d16_hi v25, v41 offset:64128
    s_mov_b64 exec, s[24:25]
    ds_write_b32 v18, v44 offset:33280
    v_lshrrev_b32 v26, 1, v18
    ds_write_b16 v26, v45 offset:64128
    ds_write_b32 v19, v46 offset:33280
    v_lshrrev_b32 v27, 1, v19
    ds_write_b16_d16_hi v27, v45 offset:64128
    s_mov_b64 exec, s[26:27]
    ds_write_b32 v20, v48 offset:33280
    v_lshrrev_b32 v28, 1, v20
    ds_write_b16 v28, v49 offset:64128
    ds_write_b32 v21, v50 offset:33280
    v_lshrrev_b32 v29, 1, v21
    ds_write_b16_d16_hi v29, v49 offset:64128
    s_mov_b64 exec, -1
    s_waitcnt vmcnt(0)
    s_mov_b64 exec, s[28:29]
    v_and_b32_sdwa v12, s52, v52 dst_sel:DWORD dst_unused:UNUSED_PAD src0_sel:DWORD src1_sel:BYTE_3
    ds_add_rtn_u32 v12, v12, v35 offset:32768
    v_and_b32_sdwa v13, s52, v54 dst_sel:DWORD dst_unused:UNUSED_PAD src0_sel:DWORD src1_sel:BYTE_3
    ds_add_rtn_u32 v13, v13, v35 offset:32768
    s_mov_b64 exec, s[30:31]
    v_and_b32_sdwa v16, s52, v56 dst_sel:DWORD dst_unused:UNUSED_PAD src0_sel:DWORD src1_sel:BYTE_3
    ds_add_rtn_u32 v16, v16, v35 offset:32768
    v_and_b32_sdwa v17, s52, v58 dst_sel:DWORD dst_unused:UNUSED_PAD src0_sel:DWORD src1_sel:BYTE_3
    ds_add_rtn_u32 v17, v17, v35 offset:32768
    s_mov_b64 exec, s[32:33]
    v_and_b32_sdwa v18, s52, v60 dst_sel:DWORD dst_unused:UNUSED_PAD src0_sel:DWORD src1_sel:BYTE_3
    ds_add_rtn_u32 v18, v18, v35 offset:32768
    v_and_b32_sdwa v19, s52, v62 dst_sel:DWORD dst_unused:UNUSED_PAD src0_sel:DWORD src1_sel:BYTE_3
    ds_add_rtn_u32 v19, v19, v35 offset:32768
    s_mov_b64 exec, s[34:35]
    v_and_b32_sdwa v20, s52, v64 dst_sel:DWORD dst_unused:UNUSED_PAD src0_sel:DWORD src1_sel:BYTE_3
    ds_add_rtn_u32 v20, v20, v35 offset:32768
    v_and_b32_sdwa v21, s52, v66 dst_sel:DWORD dst_unused:UNUSED_PAD src0_sel:DWORD src1_sel:BYTE_3
    ds_add_rtn_u32 v21, v21, v35 offset:32768
    s_mov_b64 exec, -1
    s_waitcnt lgkmcnt(0)
    s_mov_b64 exec, s[28:29]
    ds_write_b32 v12, v52 offset:33280
    v_lshrrev_b32 v22, 1, v12
    ds_write_b16 v22, v53 offset:64128
    ds_write_b32 v13, v54 offset:33280
    v_lshrrev_b32 v23, 1, v13
    ds_write_b16_d16_hi v23, v53 offset:64128
    s_mov_b64 exec, s[30:31]
    ds_write_b32 v16, v56 offset:33280
    v_lshrrev_b32 v24, 1, v16
    ds_write_b16 v24, v57 offset:64128
    ds_write_b32 v17, v58 offset:33280
    v_lshrrev_b32 v25, 1, v17
    ds_write_b16_d16_hi v25, v57 offset:64128
    s_mov_b64 exec, s[32:33]
    ds_write_b32 v18, v60 offset:33280
    v_lshrrev_b32 v26, 1, v18
    ds_write_b16 v26, v61 offset:64128
    ds_write_b32 v19, v62 offset:33280
    v_lshrrev_b32 v27, 1, v19
    ds_write_b16_d16_hi v27, v61 offset:64128
    s_mov_b64 exec, s[34:35]
    ds_write_b32 v20, v64 offset:33280
    v_lshrrev_b32 v28, 1, v20
    ds_write_b16 v28, v65 offset:64128
    ds_write_b32 v21, v66 offset:33280
    v_lshrrev_b32 v29, 1, v21
    ds_write_b16_d16_hi v29, v65 offset:64128
    s_mov_b64 exec, -1
    s_branch L_p2_pdone
L_p2_par1:
    s_waitcnt vmcnt(4)
    s_mov_b64 exec, s[20:21]
    v_and_b32_sdwa v12, s52, v36 dst_sel:DWORD dst_unused:UNUSED_PAD src0_sel:DWORD src1_sel:BYTE_3
    ds_add_rtn_u32 v12, v12, v35 offset:33024
    v_and_b32_sdwa v13, s52, v38 dst_sel:DWORD dst_unused:UNUSED_PAD src0_sel:DWORD src1_sel:BYTE_3
    ds_add_rtn_u32 v13, v13, v35 offset:33024
    s_mov_b64 exec, s[22:23]
    v_and_b32_sdwa v16, s52, v40 dst_sel:DWORD dst_unused:UNUSED_PAD src0_sel:DWORD src1_sel:BYTE_3
    ds_add_rtn_u32 v16, v16, v35 offset:33024
    v_and_b32_sdwa v17, s52, v42 dst_sel:DWORD dst_unused:UNUSED_PAD src0_sel:DWORD src1_sel:BYTE_3
    ds_add_rtn_u32 v17, v17, v35 offset:33024
    s_mov_b64 exec, s[24:25]
    v_and_b32_sdwa v18, s52, v44 dst_sel:DWORD dst_unused:UNUSED_PAD src0_sel:DWORD src1_sel:BYTE_3
    ds_add_rtn_u32 v18, v18, v35 offset:33024
    v_and_b32_sdwa v19, s52, v46 dst_sel:DWORD dst_unused:UNUSED_PAD src0_sel:DWORD src1_sel:BYTE_3
    ds_add_rtn_u32 v19, v19, v35 offset:33024
    s_mov_b64 exec, s[26:27]
    v_and_b32_sdwa v20, s52, v48 dst_sel:DWORD dst_unused:UNUSED_PAD src0_sel:DWORD src1_sel:BYTE_3
    ds_add_rtn_u32 v20, v20, v35 offset:33024
    v_and_b32_sdwa v21, s52, v50 dst_sel:DWORD dst_unused:UNUSED_PAD src0_sel:DWORD src1_sel:BYTE_3
    ds_add_rtn_u32 v21, v21, v35 offset:33024
    s_mov_b64 exec, -1
    s_waitcnt lgkmcnt(0)
    s_mov_b64 exec, s[20:21]
    ds_write_b32 v12, v36 offset:33280
    v_lshrrev_b32 v22, 1, v12
    ds_write_b16 v22, v37 offset:64128
    ds_write_b32 v13, v38 offset:33280
    v_lshrrev_b32 v23, 1, v13
    ds_write_b16_d16_hi v23, v37 offset:64128
    s_mov_b64 exec, s[22:23]
    ds_write_b32 v16, v40 offset:33280
    v_lshrrev_b32 v24, 1, v16
    ds_write_b16 v24, v41 offset:64128
    ds_write_b32 v17, v42 offset:33280
    v_lshrrev_b32 v25, 1, v17
    ds_write_b16_d16_hi v25, v41 offset:64128
    s_mov_b64 exec, s[24:25]
    ds_write_b32 v18, v44 offset:33280
    v_lshrrev_b32 v26, 1, v18
    ds_write_b16 v26, v45 offset:64128
    ds_write_b32 v19, v46 offset:33280
    v_lshrrev_b32 v27, 1, v19
    ds_write_b16_d16_hi v27, v45 offset:64128
    s_mov_b64 exec, s[26:27]
    ds_write_b32 v20, v48 offset:33280
    v_lshrrev_b32 v28, 1, v20
    ds_write_b16 v28, v49 offset:64128
    ds_write_b32 v21, v50 offset:33280
    v_lshrrev_b32 v29, 1, v21
    ds_write_b16_d16_hi v29, v49 offset:64128
    s_mov_b64 exec, -1
    s_waitcnt vmcnt(0)
    s_mov_b64 exec, s[28:29]
    v_and_b32_sdwa v12, s52, v52 dst_sel:DWORD dst_unused:UNUSED_PAD src0_sel:DWORD src1_sel:BYTE_3
    ds_add_rtn_u32 v12, v12, v35 offset:33024
    v_and_b32_sdwa v13, s52, v54 dst_sel:DWORD dst_unused:UNUSED_PAD src0_sel:DWORD src1_sel:BYTE_3
    ds_add_rtn_u32 v13, v13, v35 offset:33024
    s_mov_b64 exec, s[30:31]
    v_and_b32_sdwa v16, s52, v56 dst_sel:DWORD dst_unused:UNUSED_PAD src0_sel:DWORD src1_sel:BYTE_3
    ds_add_rtn_u32 v16, v16, v35 offset:33024
    v_and_b32_sdwa v17, s52, v58 dst_sel:DWORD dst_unused:UNUSED_PAD src0_sel:DWORD src1_sel:BYTE_3
    ds_add_rtn_u32 v17, v17, v35 offset:33024
    s_mov_b64 exec, s[32:33]
    v_and_b32_sdwa v18, s52, v60 dst_sel:DWORD dst_unused:UNUSED_PAD src0_sel:DWORD src1_sel:BYTE_3
    ds_add_rtn_u32 v18, v18, v35 offset:33024
    v_and_b32_sdwa v19, s52, v62 dst_sel:DWORD dst_unused:UNUSED_PAD src0_sel:DWORD src1_sel:BYTE_3
    ds_add_rtn_u32 v19, v19, v35 offset:33024
    s_mov_b64 exec, s[34:35]
    v_and_b32_sdwa v20, s52, v64 dst_sel:DWORD dst_unused:UNUSED_PAD src0_sel:DWORD src1_sel:BYTE_3
    ds_add_rtn_u32 v20, v20, v35 offset:33024
    v_and_b32_sdwa v21, s52, v66 dst_sel:DWORD dst_unused:UNUSED_PAD src0_sel:DWORD src1_sel:BYTE_3
    ds_add_rtn_u32 v21, v21, v35 offset:33024
    s_mov_b64 exec, -1
    s_waitcnt lgkmcnt(0)
    s_mov_b64 exec, s[28:29]
    ds_write_b32 v12, v52 offset:33280
    v_lshrrev_b32 v22, 1, v12
    ds_write_b16 v22, v53 offset:64128
    ds_write_b32 v13, v54 offset:33280
    v_lshrrev_b32 v23, 1, v13
    ds_write_b16_d16_hi v23, v53 offset:64128
    s_mov_b64 exec, s[30:31]
    ds_write_b32 v16, v56 offset:33280
    v_lshrrev_b32 v24, 1, v16
    ds_write_b16 v24, v57 offset:64128
    ds_write_b32 v17, v58 offset:33280
    v_lshrrev_b32 v25, 1, v17
    ds_write_b16_d16_hi v25, v57 offset:64128
    s_mov_b64 exec, s[32:33]
    ds_write_b32 v18, v60 offset:33280
    v_lshrrev_b32 v26, 1, v18
    ds_write_b16 v26, v61 offset:64128
    ds_write_b32 v19, v62 offset:33280
    v_lshrrev_b32 v27, 1, v19
    ds_write_b16_d16_hi v27, v61 offset:64128
    s_mov_b64 exec, s[34:35]
    ds_write_b32 v20, v64 offset:33280
    v_lshrrev_b32 v28, 1, v20
    ds_write_b16 v28, v65 offset:64128
    ds_write_b32 v21, v66 offset:33280
    v_lshrrev_b32 v29, 1, v21
    ds_write_b16_d16_hi v29, v65 offset:64128
    s_mov_b64 exec, -1
L_p2_pdone:
    s_add_u32 s17, s17, 32
    v_cmp_lt_u32 vcc, s17, v31
    s_cbranch_vccz L_p2_nomore
    s_cmp_eq_u32 s14, 0
    s_cbranch_scc1 L_p2_wloop
    v_mov_b32 v20, s54
    v_mov_b32 v21, 1
    ds_write_b32 v20, v21 offset:32992
L_p2_nomore:
    s_cmp_eq_u32 s14, 0
    s_cbranch_scc0 L_p2_pfslow
    ds_bpermute_b32 v12, v32, v3 offset:0
    ds_bpermute_b32 v13, v32, v3 offset:16
    ds_bpermute_b32 v16, v32, v3 offset:32
    ds_bpermute_b32 v17, v32, v3 offset:48
    ds_bpermute_b32 v18, v32, v3 offset:64
    ds_bpermute_b32 v19, v32, v3 offset:80
    ds_bpermute_b32 v20, v32, v3 offset:96
    ds_bpermute_b32 v21, v32, v3 offset:112
    s_waitcnt lgkmcnt(0)
    v_add_u32_sdwa v36, v12, v33 dst_sel:DWORD dst_unused:UNUSED_PAD src0_sel:WORD_0 src1_sel:DWORD
    v_add_u32_sdwa v40, v13, v33 dst_sel:DWORD dst_unused:UNUSED_PAD src0_sel:WORD_0 src1_sel:DWORD
    v_add_u32_sdwa v44, v16, v33 dst_sel:DWORD dst_unused:UNUSED_PAD src0_sel:WORD_0 src1_sel:DWORD
    v_add_u32_sdwa v48, v17, v33 dst_sel:DWORD dst_unused:UNUSED_PAD src0_sel:WORD_0 src1_sel:DWORD
    v_add_u32_sdwa v52, v18, v33 dst_sel:DWORD dst_unused:UNUSED_PAD src0_sel:WORD_0 src1_sel:DWORD
    v_add_u32_sdwa v56, v19, v33 dst_sel:DWORD dst_unused:UNUSED_PAD src0_sel:WORD_0 src1_sel:DWORD
    v_add_u32_sdwa v60, v20, v33 dst_sel:DWORD dst_unused:UNUSED_PAD src0_sel:WORD_0 src1_sel:DWORD
    v_add_u32_sdwa v64, v21, v33 dst_sel:DWORD dst_unused:UNUSED_PAD src0_sel:WORD_0 src1_sel:DWORD
    v_cmp_lt_u32_sdwa s[20:21], v36, v12 src0_sel:DWORD src1_sel:WORD_1
    v_cmp_lt_u32_sdwa s[22:23], v40, v13 src0_sel:DWORD src1_sel:WORD_1
    v_cmp_lt_u32_sdwa s[24:25], v44, v16 src0_sel:DWORD src1_sel:WORD_1
    v_cmp_lt_u32_sdwa s[26:27], v48, v17 src0_sel:DWORD src1_sel:WORD_1
    v_cmp_lt_u32_sdwa s[28:29], v52, v18 src0_sel:DWORD src1_sel:WORD_1
    v_cmp_lt_u32_sdwa s[30:31], v56, v19 src0_sel:DWORD src1_sel:WORD_1
    v_cmp_lt_u32_sdwa s[32:33], v60, v20 src0_sel:DWORD src1_sel:WORD_1
    v_cmp_lt_u32_sdwa s[34:35], v64, v21 src0_sel:DWORD src1_sel:WORD_1
    v_mad_u32_u24 v36, v36, 6, v34
    v_mad_u32_u24 v40, v40, 6, v34
    v_mad_u32_u24 v44, v44, 6, v34
    v_mad_u32_u24 v48, v48, 6, v34
    v_mad_u32_u24 v52, v52, 6, v34
    v_mad_u32_u24 v56, v56, 6, v34
    v_mad_u32_u24 v60, v60, 6, v34
    v_mad_u32_u24 v64, v64, 6, v34
    s_mov_b32 s62, 0
    s_mov_b64 exec, s[20:21]
    buffer_load_dwordx3 v[36:38], v36, s[8:11], s62 offen
    s_mov_b32 s62, 1044480
    s_mov_b64 exec, s[22:23]
    buffer_load_dwordx3 v[40:42], v40, s[8:11], s62 offen
    s_mov_b32 s62, 2088960
    s_mov_b64 exec, s[24:25]
    buffer_load_dwordx3 v[44:46], v44, s[8:11], s62 offen
    s_mov_b32 s62, 3133440
    s_mov_b64 exec, s[26:27]
    buffer_load_dwordx3 v[48:50], v48, s[8:11], s62 offen
    s_mov_b32 s62, 4177920
    s_mov_b64 exec, s[28:29]
    buffer_load_dwordx3 v[52:54], v52, s[8:11], s62 offen
    s_mov_b32 s62, 5222400
    s_mov_b64 exec, s[30:31]
    buffer_load_dwordx3 v[56:58], v56, s[8:11], s62 offen
    s_mov_b32 s62, 6266880
    s_mov_b64 exec, s[32:33]
    buffer_load_dwordx3 v[60:62], v60, s[8:11], s62 offen
    s_mov_b32 s62, 7311360
    s_mov_b64 exec, s[34:35]
    buffer_load_dwordx3 v[64:66], v64, s[8:11], s62 offen
    s_mov_b64 exec, -1
    s_mov_b32 s69, 1
    s_branch L_p2_pfd
L_p2_pfslow:
    s_mov_b64 s[20:21], 0
    s_mov_b64 s[22:23], 0
    s_mov_b64 s[24:25], 0
    s_mov_b64 s[26:27], 0
    s_mov_b64 s[28:29], 0
    s_mov_b64 s[30:31], 0
    s_mov_b64 s[32:33], 0
    s_mov_b64 s[34:35], 0
L_p2_pfd:
    s_waitcnt lgkmcnt(0)
    s_barrier
    s_cmp_eq_u32 s13, 0
    s_cbranch_scc0 L_pr_1
    s_setprio 3
L_pr_1:
    s_cmp_eq_u32 s13, 1
    s_cbranch_scc0 L_pr_2
    s_setprio 2
L_pr_2:
    s_cmp_eq_u32 s13, 2
    s_cbranch_scc0 L_pr_3
    s_setprio 1
L_pr_3:
    s_cmp_eq_u32 s13, 3
    s_cbranch_scc0 L_pr_4
    s_setprio 0
L_pr_4:
    s_cmp_eq_u32 s13, 4
    s_cbranch_scc0 L_pr_5
    s_setprio 0
L_pr_5:
    v_add_u32 v18, s46, v15
    ds_read_b32 v16, v18
    ds_read_b32 v17, v18 offset:128
    ds_read_b32 v31, v11 offset:32768
    s_mov_b32 m0, s49
    s_waitcnt lgkmcnt(1)
    v_and_or_b32 v16, v16, s53, v6
    v_and_or_b32 v17, v17, s53, v6
    buffer_load_dwordx4 v16, s[4:7], 0 idxen lds
    s_add_u32 m0, s49, 1024
    s_nop 0
    buffer_load_dwordx4 v17, s[4:7], 0 idxen lds
    v_xor_b32 v11, 256, v11
    s_xor_b32 s54, s54, 256
    s_cmp_eq_u32 s13, 4
    s_cselect_b32 s57, 1, s14
    s_cmp_eq_u32 s57, 0
    s_cselect_b32 s51, 0x7c, 0
    s_waitcnt lgkmcnt(0)
    v_readlane_b32 s18, v31, 56
    v_sub_u32 v31, v31, v10
    s_movk_i32 s50, 768
    v_cmp_lt_u32 vcc, s50, v31
    s_mov_b32 s60, 0xfffffff0
    s_mov_b32 s61, 0xfff
    s_and_b64 s[60:61], s[60:61], vcc
    s_cselect_b32 s19, 1, 0
    s_cbranch_scc0 L_p2_noovf
    s_mov_b32 s69, 0
    ds_write_b32 v11, v39 offset:32768
    v_and_b32 v16, 0xff, v11
    v_and_b32 v17, 0x7c, v16
    v_lshrrev_b32 v19, 7, v16
    v_mul_u32_u24 v19, 768, v19
    v_add3_u32 v19, v19, s46, v17
    v_lshrrev_b32 v23, 1, v19
    v_add_u32 v23, 4096, v23
    s_waitcnt lgkmcnt(0)
    ds_write_b32 v19, v43 offset:33280
    ds_write_b16 v23, v59 offset:60032
    ds_write_b32 v19, v51 offset:34816
    ds_write_b16 v23, v63 offset:60800
    s_mov_b32 exec_hi, 0
    ds_write_b32 v19, v55 offset:36352
    ds_write_b16 v23, v67 offset:61568
    s_mov_b64 exec, -1
    v_and_b32 v16, 0x7c, v11
    v_mov_b32 v17, -1
    ds_write_b32 v16, v17 offset:64000
    s_branch L_p2_skipc
L_p2_noovf:
    v_and_b32 v39, s51, v31
    v_and_b32 v0, 0xffffff80, v31
    v_add_u32 v39, v39, v10
    v_add_u32 v0, v0, v10
    ds_write_b32 v11, v39 offset:32768
    s_add_u32 s50, s55, 0
    v_readlane_b32 s36, v31, s50
    s_add_u32 s50, s55, 1
    v_readlane_b32 s37, v31, s50
    s_add_u32 s50, s55, 2
    v_readlane_b32 s38, v31, s50
    s_add_u32 s50, s55, 3
    v_readlane_b32 s39, v31, s50
    s_add_u32 s50, s55, 4
    v_readlane_b32 s40, v31, s50
    s_cmp_ge_u32 s36, 256
    s_cselect_b32 s44, 1, 0
    v_and_b32 v28, 0xff, v11
    s_cmp_eq_u32 s57, 0
    s_cbranch_scc1 L_nofl_6
    v_mov_b32 v29, -1
    s_add_u32 s50, s36, 127
    s_andn2_b32 s50, s50, 127
    v_add_u32 v30, s36, v28
    v_cmpx_gt_u32 vcc, s50, v30
    s_add_u32 s51, s46, 0
    v_add_u32 v30, s51, v30
    ds_write_b32 v30, v29 offset:33280
    s_mov_b64 exec, -1
    s_mov_b32 s36, s50
    s_add_u32 s50, s37, 127
    s_andn2_b32 s50, s50, 127
    v_add_u32 v30, s37, v28
    v_cmpx_gt_u32 vcc, s50, v30
    s_add_u32 s51, s46, 768
    v_add_u32 v30, s51, v30
    ds_write_b32 v30, v29 offset:33280
    s_mov_b64 exec, -1
    s_mov_b32 s37, s50
    s_add_u32 s50, s38, 127
    s_andn2_b32 s50, s50, 127
    v_add_u32 v30, s38, v28
    v_cmpx_gt_u32 vcc, s50, v30
    s_add_u32 s51, s46, 1536
    v_add_u32 v30, s51, v30
    ds_write_b32 v30, v29 offset:33280
    s_mov_b64 exec, -1
    s_mov_b32 s38, s50
    s_add_u32 s50, s39, 127
    s_andn2_b32 s50, s50, 127
    v_add_u32 v30, s39, v28
    v_cmpx_gt_u32 vcc, s50, v30
    s_add_u32 s51, s46, 2304
    v_add_u32 v30, s51, v30
    ds_write_b32 v30, v29 offset:33280
    s_mov_b64 exec, -1
    s_mov_b32 s39, s50
    s_add_u32 s50, s40, 127
    s_andn2_b32 s50, s50, 127
    v_add_u32 v30, s40, v28
    v_cmpx_gt_u32 vcc, s50, v30
    s_add_u32 s51, s46, 3072
    v_add_u32 v30, s51, v30
    ds_write_b32 v30, v29 offset:33280
    s_mov_b64 exec, -1
    s_mov_b32 s40, s50
L_nofl_6:
    s_lshr_b32 s36, s36, 7
    s_lshr_b32 s37, s37, 7
    s_lshr_b32 s38, s38, 7
    s_lshr_b32 s39, s39, 7
    s_lshr_b32 s40, s40, 7
    v_mov_b32 v43, s46
    s_mov_b32 s50, 0
    s_add_u32 s50, s50, s36
    s_lshl_b32 s51, s50, 7
    s_sub_u32 s51, s46, s51
    s_add_u32 s51, s51, 768
    s_lshl_b64 exec, -1, s50
    v_mov_b32 v43, s51
    s_add_u32 s50, s50, s37
    s_lshl_b32 s51, s50, 7
    s_sub_u32 s51, s46, s51
    s_add_u32 s51, s51, 1536
    s_lshl_b64 exec, -1, s50
    v_mov_b32 v43, s51
    s_add_u32 s50, s50, s38
    s_lshl_b32 s51, s50, 7
    s_sub_u32 s51, s46, s51
    s_add_u32 s51, s51, 2304
    s_lshl_b64 exec, -1, s50
    v_mov_b32 v43, s51
    s_add_u32 s50, s50, s39
    s_lshl_b32 s51, s50, 7
    s_sub_u32 s51, s46, s51
    s_add_u32 s51, s51, 3072
    s_lshl_b64 exec, -1, s50
    v_mov_b32 v43, s51
    s_add_u32 s50, s50, s40
    s_mov_b64 exec, -1
    v_lshl_add_u32 v43, v28, 5, v43
    s_lshl_b64 exec, -1, s50
    v_mov_b32 v43, 30720
    s_mov_b64 exec, -1
    s_cmp_eq_u32 s50, 0
    s_cbranch_scc1 L_cend_8
    v_lshrrev_b32 v51, 2, v28
    v_and_b32 v51, 12, v51
    ds_bpermute_b32 v63, v51, v43
    v_add_u32 v51, 16, v51
    s_cmp_eq_u32 s44, 0
    s_cbranch_scc1 L_nsp_10
    s_mov_b32 s63, 2
    s_mov_b32 s50, 3
    s_waitcnt lgkmcnt(0)
    v_add_u32 v63, v63, v1
    v_lshrrev_b32 v67, 1, v63
    ds_read_b64 v[12:13], v63
    ds_read_u16_d16_hi v63, v67 offset:47488
    ds_read_u16_d16_hi v67, v67 offset:47490
    s_branch L_spd_11
L_nsp_10:
    s_mov_b32 s63, 0
    s_mov_b32 s50, 1
    v_readlane_b32 s51, v43, s63
    v_readlane_b32 s50, v43, s50
    s_add_u32 s63, s63, 2
    v_add_u32 v55, s51, v15
    v_add_u32 v59, s50, v15
    ds_read_b32 v55, v55
    ds_read_b32 v59, v59
    s_waitcnt lgkmcnt(0)
    v_add_u32 v63, v63, v1
    v_lshrrev_b32 v67, 1, v63
    ds_read_b64 v[12:13], v63
    ds_read_u16_d16_hi v63, v67 offset:47488
    ds_read_u16_d16_hi v67, v67 offset:47490
    s_add_u32 m0, s49, 0
    v_and_or_b32 v55, v55, s53, v6
    v_and_or_b32 v59, v59, s53, v6
    buffer_load_dwordx4 v55, s[4:7], 0 idxen lds
    s_add_u32 m0, s49, 1024
    s_add_u32 s50, s63, 1
    buffer_load_dwordx4 v59, s[4:7], 0 idxen lds
L_spd_11:
    v_readlane_b32 s51, v43, s63
    v_readlane_b32 s50, v43, s50
    s_add_u32 s63, s63, 2
    v_add_u32 v55, s51, v15
    v_add_u32 v59, s50, v15
    ds_read_b32 v55, v55
    ds_read_b32 v59, v59
    s_waitcnt lgkmcnt(2)
    v_mul_f32 v20, 0.15915494, v63
    v_mul_f32 v21, 0.15915494, v67
    v_mul_f32 v22, 0x40400000, v63
    v_mul_f32 v23, 0x40400000, v67
    v_perm_b32 v26, v13, v12, s48
    v_cvt_pk_bf16_f32 v22, 0, v22
    v_cvt_pk_bf16_f32 v23, 0, v23
    v_cos_f32 v20, v20
    v_cos_f32 v21, v21
    v_mul_f32 v22, 0.15915494, v22
    v_mul_f32 v23, 0.15915494, v23
    v_pk_lshrrev_b16 v26, 5, v26 op_sel_hi:[0,1]
    v_cos_f32 v22, v22
    v_cos_f32 v23, v23
    v_add_f32 v24, v20, v20
    v_add_f32 v25, v21, v21
    v_and_b32 v32, s47, v26
    v_fma_f32 v24, v24, v20, -1.0
    v_fma_f32 v25, v25, v21, -1.0
    v_cvt_pk_bf16_f32 v33, v20, v21
    v_cvt_pk_bf16_f32 v35, v22, v23
    v_cvt_pk_bf16_f32 v34, v24, v25
    s_branch L_en0_0__12
L_bd0_0__32:
    s_waitcnt lgkmcnt(0)
    s_add_u32 m0, s49, 2048
    v_and_or_b32 v55, v55, s53, v6
    v_and_or_b32 v59, v59, s53, v6
    buffer_load_dwordx4 v55, s[4:7], 0 idxen lds
    s_add_u32 m0, s49, 3072
    s_add_u32 s50, s63, 1
    buffer_load_dwordx4 v59, s[4:7], 0 idxen lds
    v_readlane_b32 s51, v43, s63
    v_readlane_b32 s50, v43, s50
    s_add_u32 s63, s63, 2
    v_add_u32 v55, s51, v15
    v_add_u32 v59, s50, v15
    ds_read_b32 v55, v55
    ds_read_b32 v59, v59
    ds_bpermute_b32 v63, v51, v43
    v_add_u32 v51, 16, v51
    s_waitcnt vmcnt(2)
    ds_read_b64_tr_b16 v[28:29], v7 offset:0
    ds_read_b64_tr_b16 v[30:31], v8 offset:0
    v_xor_b32_dpp v16, v32, v14 row_newbcast:0 row_mask:0xf bank_mask:0xf
    v_xor_b32_dpp v17, v32, v14 row_newbcast:1 row_mask:0xf bank_mask:0xf
    v_xor_b32_dpp v18, v32, v14 row_newbcast:2 row_mask:0xf bank_mask:0xf
    v_xor_b32_dpp v19, v32, v14 row_newbcast:3 row_mask:0xf bank_mask:0xf
    v_pk_add_u16 v16, v16, -1
    v_pk_add_u16 v17, v17, -1
    v_pk_add_u16 v18, v18, -1
    v_pk_add_u16 v19, v19, -1
    v_pk_ashrrev_i16 v16, 15, v16 op_sel_hi:[0,1]
    v_pk_ashrrev_i16 v17, 15, v17 op_sel_hi:[0,1]
    v_pk_ashrrev_i16 v18, 15, v18 op_sel_hi:[0,1]
    v_pk_ashrrev_i16 v19, 15, v19 op_sel_hi:[0,1]
    v_and_b32_dpp v20, v33, v16 row_newbcast:0 row_mask:0xf bank_mask:0xf
    v_and_b32_dpp v21, v33, v17 row_newbcast:1 row_mask:0xf bank_mask:0xf
    v_and_b32_dpp v22, v33, v18 row_newbcast:2 row_mask:0xf bank_mask:0xf
    v_and_b32_dpp v23, v33, v19 row_newbcast:3 row_mask:0xf bank_mask:0xf
    v_and_b32_dpp v24, v34, v16 row_newbcast:0 row_mask:0xf bank_mask:0xf
    v_and_b32_dpp v25, v34, v17 row_newbcast:1 row_mask:0xf bank_mask:0xf
    v_and_b32_dpp v26, v34, v18 row_newbcast:2 row_mask:0xf bank_mask:0xf
    v_and_b32_dpp v27, v34, v19 row_newbcast:3 row_mask:0xf bank_mask:0xf
    s_waitcnt lgkmcnt(0)
    v_mfma_f32_16x16x32_bf16 v[68:71], v[28:31], v[20:23], v[68:71]
    v_mfma_f32_16x16x32_bf16 v[72:75], v[28:31], v[24:27], v[72:75]
    v_and_b32_dpp v20, v35, v16 row_newbcast:0 row_mask:0xf bank_mask:0xf
    v_and_b32_dpp v21, v35, v17 row_newbcast:1 row_mask:0xf bank_mask:0xf
    v_and_b32_dpp v22, v35, v18 row_newbcast:2 row_mask:0xf bank_mask:0xf
    v_and_b32_dpp v23, v35, v19 row_newbcast:3 row_mask:0xf bank_mask:0xf
    s_nop 1
    v_mfma_f32_16x16x32_bf16 v[76:79], v[28:31], v[20:23], v[76:79]
    s_sub_u32 s41, s41, 1
    s_cbranch_scc1 L_en1_1__17
L_bd0_1__33:
    ds_read_b64_tr_b16 v[28:29], v7 offset:1024
    ds_read_b64_tr_b16 v[30:31], v8 offset:1024
    v_add_u32 v63, v63, v1
    v_lshrrev_b32 v67, 1, v63
    ds_read_b64 v[12:13], v63
    ds_read_u16_d16_hi v63, v67 offset:47488
    ds_read_u16_d16_hi v67, v67 offset:47490
    v_xor_b32_dpp v16, v32, v14 row_newbcast:4 row_mask:0xf bank_mask:0xf
    v_xor_b32_dpp v17, v32, v14 row_newbcast:5 row_mask:0xf bank_mask:0xf
    v_xor_b32_dpp v18, v32, v14 row_newbcast:6 row_mask:0xf bank_mask:0xf
    v_xor_b32_dpp v19, v32, v14 row_newbcast:7 row_mask:0xf bank_mask:0xf
    v_pk_add_u16 v16, v16, -1
    v_pk_add_u16 v17, v17, -1
    v_pk_add_u16 v18, v18, -1
    v_pk_add_u16 v19, v19, -1
    v_pk_ashrrev_i16 v16, 15, v16 op_sel_hi:[0,1]
    v_pk_ashrrev_i16 v17, 15, v17 op_sel_hi:[0,1]
    v_pk_ashrrev_i16 v18, 15, v18 op_sel_hi:[0,1]
    v_pk_ashrrev_i16 v19, 15, v19 op_sel_hi:[0,1]
    v_and_b32_dpp v20, v33, v16 row_newbcast:4 row_mask:0xf bank_mask:0xf
    v_and_b32_dpp v21, v33, v17 row_newbcast:5 row_mask:0xf bank_mask:0xf
    v_and_b32_dpp v22, v33, v18 row_newbcast:6 row_mask:0xf bank_mask:0xf
    v_and_b32_dpp v23, v33, v19 row_newbcast:7 row_mask:0xf bank_mask:0xf
    v_and_b32_dpp v24, v34, v16 row_newbcast:4 row_mask:0xf bank_mask:0xf
    v_and_b32_dpp v25, v34, v17 row_newbcast:5 row_mask:0xf bank_mask:0xf
    v_and_b32_dpp v26, v34, v18 row_newbcast:6 row_mask:0xf bank_mask:0xf
    v_and_b32_dpp v27, v34, v19 row_newbcast:7 row_mask:0xf bank_mask:0xf
    s_waitcnt lgkmcnt(0)
    v_mfma_f32_16x16x32_bf16 v[68:71], v[28:31], v[20:23], v[68:71]
    v_mfma_f32_16x16x32_bf16 v[72:75], v[28:31], v[24:27], v[72:75]
    v_and_b32_dpp v20, v35, v16 row_newbcast:4 row_mask:0xf bank_mask:0xf
    v_and_b32_dpp v21, v35, v17 row_newbcast:5 row_mask:0xf bank_mask:0xf
    v_and_b32_dpp v22, v35, v18 row_newbcast:6 row_mask:0xf bank_mask:0xf
    v_and_b32_dpp v23, v35, v19 row_newbcast:7 row_mask:0xf bank_mask:0xf
    s_nop 1
    v_mfma_f32_16x16x32_bf16 v[76:79], v[28:31], v[20:23], v[76:79]
    s_sub_u32 s41, s41, 1
    s_cbranch_scc1 L_en1_2__18
L_bd0_2__34:
    s_add_u32 m0, s49, 0
    v_and_or_b32 v55, v55, s53, v6
    v_and_or_b32 v59, v59, s53, v6
    buffer_load_dwordx4 v55, s[4:7], 0 idxen lds
    s_add_u32 m0, s49, 1024
    s_add_u32 s50, s63, 1
    buffer_load_dwordx4 v59, s[4:7], 0 idxen lds
    v_readlane_b32 s51, v43, s63
    v_readlane_b32 s50, v43, s50
    s_add_u32 s63, s63, 2
    v_add_u32 v55, s51, v15
    v_add_u32 v59, s50, v15
    ds_read_b32 v55, v55
    ds_read_b32 v59, v59
    s_waitcnt vmcnt(2)
    ds_read_b64_tr_b16 v[28:29], v7 offset:2048
    ds_read_b64_tr_b16 v[30:31], v8 offset:2048
    v_xor_b32_dpp v16, v32, v14 row_newbcast:8 row_mask:0xf bank_mask:0xf
    v_xor_b32_dpp v17, v32, v14 row_newbcast:9 row_mask:0xf bank_mask:0xf
    v_xor_b32_dpp v18, v32, v14 row_newbcast:10 row_mask:0xf bank_mask:0xf
    v_xor_b32_dpp v19, v32, v14 row_newbcast:11 row_mask:0xf bank_mask:0xf
    v_pk_add_u16 v16, v16, -1
    v_pk_add_u16 v17, v17, -1
    v_pk_add_u16 v18, v18, -1
    v_pk_add_u16 v19, v19, -1
    v_pk_ashrrev_i16 v16, 15, v16 op_sel_hi:[0,1]
    v_pk_ashrrev_i16 v17, 15, v17 op_sel_hi:[0,1]
    v_pk_ashrrev_i16 v18, 15, v18 op_sel_hi:[0,1]
    v_pk_ashrrev_i16 v19, 15, v19 op_sel_hi:[0,1]
    v_and_b32_dpp v20, v33, v16 row_newbcast:8 row_mask:0xf bank_mask:0xf
    v_and_b32_dpp v21, v33, v17 row_newbcast:9 row_mask:0xf bank_mask:0xf
    v_and_b32_dpp v22, v33, v18 row_newbcast:10 row_mask:0xf bank_mask:0xf
    v_and_b32_dpp v23, v33, v19 row_newbcast:11 row_mask:0xf bank_mask:0xf
    v_and_b32_dpp v24, v34, v16 row_newbcast:8 row_mask:0xf bank_mask:0xf
    v_and_b32_dpp v25, v34, v17 row_newbcast:9 row_mask:0xf bank_mask:0xf
    v_and_b32_dpp v26, v34, v18 row_newbcast:10 row_mask:0xf bank_mask:0xf
    v_and_b32_dpp v27, v34, v19 row_newbcast:11 row_mask:0xf bank_mask:0xf
    s_waitcnt lgkmcnt(0)
    v_mfma_f32_16x16x32_bf16 v[68:71], v[28:31], v[20:23], v[68:71]
    v_mfma_f32_16x16x32_bf16 v[72:75], v[28:31], v[24:27], v[72:75]
    v_and_b32_dpp v20, v35, v16 row_newbcast:8 row_mask:0xf bank_mask:0xf
    v_and_b32_dpp v21, v35, v17 row_newbcast:9 row_mask:0xf bank_mask:0xf
    v_and_b32_dpp v22, v35, v18 row_newbcast:10 row_mask:0xf bank_mask:0xf
    v_and_b32_dpp v23, v35, v19 row_newbcast:11 row_mask:0xf bank_mask:0xf
    s_nop 1
    v_mfma_f32_16x16x32_bf16 v[76:79], v[28:31], v[20:23], v[76:79]
    s_sub_u32 s41, s41, 1
    s_cbranch_scc1 L_en1_3__19
L_bd0_3__35:
    ds_read_b64_tr_b16 v[28:29], v7 offset:3072
    ds_read_b64_tr_b16 v[30:31], v8 offset:3072
    v_xor_b32_dpp v16, v32, v14 row_newbcast:12 row_mask:0xf bank_mask:0xf
    v_xor_b32_dpp v17, v32, v14 row_newbcast:13 row_mask:0xf bank_mask:0xf
    v_xor_b32_dpp v18, v32, v14 row_newbcast:14 row_mask:0xf bank_mask:0xf
    v_xor_b32_dpp v19, v32, v14 row_newbcast:15 row_mask:0xf bank_mask:0xf
    v_pk_add_u16 v16, v16, -1
    v_pk_add_u16 v17, v17, -1
    v_pk_add_u16 v18, v18, -1
    v_pk_add_u16 v19, v19, -1
    v_pk_ashrrev_i16 v16, 15, v16 op_sel_hi:[0,1]
    v_pk_ashrrev_i16 v17, 15, v17 op_sel_hi:[0,1]
    v_pk_ashrrev_i16 v18, 15, v18 op_sel_hi:[0,1]
    v_pk_ashrrev_i16 v19, 15, v19 op_sel_hi:[0,1]
    v_and_b32_dpp v20, v33, v16 row_newbcast:12 row_mask:0xf bank_mask:0xf
    v_and_b32_dpp v21, v33, v17 row_newbcast:13 row_mask:0xf bank_mask:0xf
    v_and_b32_dpp v22, v33, v18 row_newbcast:14 row_mask:0xf bank_mask:0xf
    v_and_b32_dpp v23, v33, v19 row_newbcast:15 row_mask:0xf bank_mask:0xf
    v_and_b32_dpp v24, v34, v16 row_newbcast:12 row_mask:0xf bank_mask:0xf
    v_and_b32_dpp v25, v34, v17 row_newbcast:13 row_mask:0xf bank_mask:0xf
    v_and_b32_dpp v26, v34, v18 row_newbcast:14 row_mask:0xf bank_mask:0xf
    v_and_b32_dpp v27, v34, v19 row_newbcast:15 row_mask:0xf bank_mask:0xf
    s_waitcnt lgkmcnt(0)
    v_mfma_f32_16x16x32_bf16 v[68:71], v[28:31], v[20:23], v[68:71]
    v_mfma_f32_16x16x32_bf16 v[72:75], v[28:31], v[24:27], v[72:75]
    v_and_b32_dpp v20, v35, v16 row_newbcast:12 row_mask:0xf bank_mask:0xf
    v_and_b32_dpp v21, v35, v17 row_newbcast:13 row_mask:0xf bank_mask:0xf
    v_and_b32_dpp v22, v35, v18 row_newbcast:14 row_mask:0xf bank_mask:0xf
    v_and_b32_dpp v23, v35, v19 row_newbcast:15 row_mask:0xf bank_mask:0xf
    s_nop 1
    v_mfma_f32_16x16x32_bf16 v[76:79], v[28:31], v[20:23], v[76:79]
    v_mul_f32 v20, 0.15915494, v63
    v_mul_f32 v21, 0.15915494, v67
    v_mul_f32 v22, 0x40400000, v63
    v_mul_f32 v23, 0x40400000, v67
    v_perm_b32 v26, v13, v12, s48
    v_cvt_pk_bf16_f32 v22, 0, v22
    v_cvt_pk_bf16_f32 v23, 0, v23
    v_cos_f32 v20, v20
    v_cos_f32 v21, v21
    v_mul_f32 v22, 0.15915494, v22
    v_mul_f32 v23, 0.15915494, v23
    v_pk_lshrrev_b16 v26, 5, v26 op_sel_hi:[0,1]
    v_cos_f32 v22, v22
    v_cos_f32 v23, v23
    v_add_f32 v24, v20, v20
    v_add_f32 v25, v21, v21
    v_and_b32 v32, s47, v26
    v_fma_f32 v24, v24, v20, -1.0
    v_fma_f32 v25, v25, v21, -1.0
    v_cvt_pk_bf16_f32 v33, v20, v21
    v_cvt_pk_bf16_f32 v35, v22, v23
    v_cvt_pk_bf16_f32 v34, v24, v25
    s_sub_u32 s41, s41, 1
    s_cbranch_scc1 L_en1_0__16
    s_branch L_bd0_0__32
L_bd1_0__36:
    s_waitcnt lgkmcnt(0)
    s_add_u32 m0, s49, 2048
    v_and_or_b32 v55, v55, s53, v6
    v_and_or_b32 v59, v59, s53, v6
    buffer_load_dwordx4 v55, s[4:7], 0 idxen lds
    s_add_u32 m0, s49, 3072
    s_add_u32 s50, s63, 1
    buffer_load_dwordx4 v59, s[4:7], 0 idxen lds
    v_readlane_b32 s51, v43, s63
    v_readlane_b32 s50, v43, s50
    s_add_u32 s63, s63, 2
    v_add_u32 v55, s51, v15
    v_add_u32 v59, s50, v15
    ds_read_b32 v55, v55
    ds_read_b32 v59, v59
    ds_bpermute_b32 v63, v51, v43
    v_add_u32 v51, 16, v51
    s_waitcnt vmcnt(2)
    ds_read_b64_tr_b16 v[28:29], v7 offset:0
    ds_read_b64_tr_b16 v[30:31], v8 offset:0
    v_xor_b32_dpp v16, v32, v14 row_newbcast:0 row_mask:0xf bank_mask:0xf
    v_xor_b32_dpp v17, v32, v14 row_newbcast:1 row_mask:0xf bank_mask:0xf
    v_xor_b32_dpp v18, v32, v14 row_newbcast:2 row_mask:0xf bank_mask:0xf
    v_xor_b32_dpp v19, v32, v14 row_newbcast:3 row_mask:0xf bank_mask:0xf
    v_pk_add_u16 v16, v16, -1
    v_pk_add_u16 v17, v17, -1
    v_pk_add_u16 v18, v18, -1
    v_pk_add_u16 v19, v19, -1
    v_pk_ashrrev_i16 v16, 15, v16 op_sel_hi:[0,1]
    v_pk_ashrrev_i16 v17, 15, v17 op_sel_hi:[0,1]
    v_pk_ashrrev_i16 v18, 15, v18 op_sel_hi:[0,1]
    v_pk_ashrrev_i16 v19, 15, v19 op_sel_hi:[0,1]
    v_and_b32_dpp v20, v33, v16 row_newbcast:0 row_mask:0xf bank_mask:0xf
    v_and_b32_dpp v21, v33, v17 row_newbcast:1 row_mask:0xf bank_mask:0xf
    v_and_b32_dpp v22, v33, v18 row_newbcast:2 row_mask:0xf bank_mask:0xf
    v_and_b32_dpp v23, v33, v19 row_newbcast:3 row_mask:0xf bank_mask:0xf
    v_and_b32_dpp v24, v34, v16 row_newbcast:0 row_mask:0xf bank_mask:0xf
    v_and_b32_dpp v25, v34, v17 row_newbcast:1 row_mask:0xf bank_mask:0xf
    v_and_b32_dpp v26, v34, v18 row_newbcast:2 row_mask:0xf bank_mask:0xf
    v_and_b32_dpp v27, v34, v19 row_newbcast:3 row_mask:0xf bank_mask:0xf
    s_waitcnt lgkmcnt(0)
    v_mfma_f32_16x16x32_bf16 v[80:83], v[28:31], v[20:23], v[80:83]
    v_mfma_f32_16x16x32_bf16 v[84:87], v[28:31], v[24:27], v[84:87]
    v_and_b32_dpp v20, v35, v16 row_newbcast:0 row_mask:0xf bank_mask:0xf
    v_and_b32_dpp v21, v35, v17 row_newbcast:1 row_mask:0xf bank_mask:0xf
    v_and_b32_dpp v22, v35, v18 row_newbcast:2 row_mask:0xf bank_mask:0xf
    v_and_b32_dpp v23, v35, v19 row_newbcast:3 row_mask:0xf bank_mask:0xf
    s_nop 1
    v_mfma_f32_16x16x32_bf16 v[88:91], v[28:31], v[20:23], v[88:91]
    s_sub_u32 s41, s41, 1
    s_cbranch_scc1 L_en2_1__21
L_bd1_1__37:
    ds_read_b64_tr_b16 v[28:29], v7 offset:1024
    ds_read_b64_tr_b16 v[30:31], v8 offset:1024
    v_add_u32 v63, v63, v1
    v_lshrrev_b32 v67, 1, v63
    ds_read_b64 v[12:13], v63
    ds_read_u16_d16_hi v63, v67 offset:47488
    ds_read_u16_d16_hi v67, v67 offset:47490
    v_xor_b32_dpp v16, v32, v14 row_newbcast:4 row_mask:0xf bank_mask:0xf
    v_xor_b32_dpp v17, v32, v14 row_newbcast:5 row_mask:0xf bank_mask:0xf
    v_xor_b32_dpp v18, v32, v14 row_newbcast:6 row_mask:0xf bank_mask:0xf
    v_xor_b32_dpp v19, v32, v14 row_newbcast:7 row_mask:0xf bank_mask:0xf
    v_pk_add_u16 v16, v16, -1
    v_pk_add_u16 v17, v17, -1
    v_pk_add_u16 v18, v18, -1
    v_pk_add_u16 v19, v19, -1
    v_pk_ashrrev_i16 v16, 15, v16 op_sel_hi:[0,1]
    v_pk_ashrrev_i16 v17, 15, v17 op_sel_hi:[0,1]
    v_pk_ashrrev_i16 v18, 15, v18 op_sel_hi:[0,1]
    v_pk_ashrrev_i16 v19, 15, v19 op_sel_hi:[0,1]
    v_and_b32_dpp v20, v33, v16 row_newbcast:4 row_mask:0xf bank_mask:0xf
    v_and_b32_dpp v21, v33, v17 row_newbcast:5 row_mask:0xf bank_mask:0xf
    v_and_b32_dpp v22, v33, v18 row_newbcast:6 row_mask:0xf bank_mask:0xf
    v_and_b32_dpp v23, v33, v19 row_newbcast:7 row_mask:0xf bank_mask:0xf
    v_and_b32_dpp v24, v34, v16 row_newbcast:4 row_mask:0xf bank_mask:0xf
    v_and_b32_dpp v25, v34, v17 row_newbcast:5 row_mask:0xf bank_mask:0xf
    v_and_b32_dpp v26, v34, v18 row_newbcast:6 row_mask:0xf bank_mask:0xf
    v_and_b32_dpp v27, v34, v19 row_newbcast:7 row_mask:0xf bank_mask:0xf
    s_waitcnt lgkmcnt(0)
    v_mfma_f32_16x16x32_bf16 v[80:83], v[28:31], v[20:23], v[80:83]
    v_mfma_f32_16x16x32_bf16 v[84:87], v[28:31], v[24:27], v[84:87]
    v_and_b32_dpp v20, v35, v16 row_newbcast:4 row_mask:0xf bank_mask:0xf
    v_and_b32_dpp v21, v35, v17 row_newbcast:5 row_mask:0xf bank_mask:0xf
    v_and_b32_dpp v22, v35, v18 row_newbcast:6 row_mask:0xf bank_mask:0xf
    v_and_b32_dpp v23, v35, v19 row_newbcast:7 row_mask:0xf bank_mask:0xf
    s_nop 1
    v_mfma_f32_16x16x32_bf16 v[88:91], v[28:31], v[20:23], v[88:91]
    s_sub_u32 s41, s41, 1
    s_cbranch_scc1 L_en2_2__22
L_bd1_2__38:
    s_add_u32 m0, s49, 0
    v_and_or_b32 v55, v55, s53, v6
    v_and_or_b32 v59, v59, s53, v6
    buffer_load_dwordx4 v55, s[4:7], 0 idxen lds
    s_add_u32 m0, s49, 1024
    s_add_u32 s50, s63, 1
    buffer_load_dwordx4 v59, s[4:7], 0 idxen lds
    v_readlane_b32 s51, v43, s63
    v_readlane_b32 s50, v43, s50
    s_add_u32 s63, s63, 2
    v_add_u32 v55, s51, v15
    v_add_u32 v59, s50, v15
    ds_read_b32 v55, v55
    ds_read_b32 v59, v59
    s_waitcnt vmcnt(2)
    ds_read_b64_tr_b16 v[28:29], v7 offset:2048
    ds_read_b64_tr_b16 v[30:31], v8 offset:2048
    v_xor_b32_dpp v16, v32, v14 row_newbcast:8 row_mask:0xf bank_mask:0xf
    v_xor_b32_dpp v17, v32, v14 row_newbcast:9 row_mask:0xf bank_mask:0xf
    v_xor_b32_dpp v18, v32, v14 row_newbcast:10 row_mask:0xf bank_mask:0xf
    v_xor_b32_dpp v19, v32, v14 row_newbcast:11 row_mask:0xf bank_mask:0xf
    v_pk_add_u16 v16, v16, -1
    v_pk_add_u16 v17, v17, -1
    v_pk_add_u16 v18, v18, -1
    v_pk_add_u16 v19, v19, -1
    v_pk_ashrrev_i16 v16, 15, v16 op_sel_hi:[0,1]
    v_pk_ashrrev_i16 v17, 15, v17 op_sel_hi:[0,1]
    v_pk_ashrrev_i16 v18, 15, v18 op_sel_hi:[0,1]
    v_pk_ashrrev_i16 v19, 15, v19 op_sel_hi:[0,1]
    v_and_b32_dpp v20, v33, v16 row_newbcast:8 row_mask:0xf bank_mask:0xf
    v_and_b32_dpp v21, v33, v17 row_newbcast:9 row_mask:0xf bank_mask:0xf
    v_and_b32_dpp v22, v33, v18 row_newbcast:10 row_mask:0xf bank_mask:0xf
    v_and_b32_dpp v23, v33, v19 row_newbcast:11 row_mask:0xf bank_mask:0xf
    v_and_b32_dpp v24, v34, v16 row_newbcast:8 row_mask:0xf bank_mask:0xf
    v_and_b32_dpp v25, v34, v17 row_newbcast:9 row_mask:0xf bank_mask:0xf
    v_and_b32_dpp v26, v34, v18 row_newbcast:10 row_mask:0xf bank_mask:0xf
    v_and_b32_dpp v27, v34, v19 row_newbcast:11 row_mask:0xf bank_mask:0xf
    s_waitcnt lgkmcnt(0)
    v_mfma_f32_16x16x32_bf16 v[80:83], v[28:31], v[20:23], v[80:83]
    v_mfma_f32_16x16x32_bf16 v[84:87], v[28:31], v[24:27], v[84:87]
    v_and_b32_dpp v20, v35, v16 row_newbcast:8 row_mask:0xf bank_mask:0xf
    v_and_b32_dpp v21, v35, v17 row_newbcast:9 row_mask:0xf bank_mask:0xf
    v_and_b32_dpp v22, v35, v18 row_newbcast:10 row_mask:0xf bank_mask:0xf
    v_and_b32_dpp v23, v35, v19 row_newbcast:11 row_mask:0xf bank_mask:0xf
    s_nop 1
    v_mfma_f32_16x16x32_bf16 v[88:91], v[28:31], v[20:23], v[88:91]
    s_sub_u32 s41, s41, 1
    s_cbranch_scc1 L_en2_3__23
L_bd1_3__39:
    ds_read_b64_tr_b16 v[28:29], v7 offset:3072
    ds_read_b64_tr_b16 v[30:31], v8 offset:3072
    v_xor_b32_dpp v16, v32, v14 row_newbcast:12 row_mask:0xf bank_mask:0xf
    v_xor_b32_dpp v17, v32, v14 row_newbcast:13 row_mask:0xf bank_mask:0xf
    v_xor_b32_dpp v18, v32, v14 row_newbcast:14 row_mask:0xf bank_mask:0xf
    v_xor_b32_dpp v19, v32, v14 row_newbcast:15 row_mask:0xf bank_mask:0xf
    v_pk_add_u16 v16, v16, -1
    v_pk_add_u16 v17, v17, -1
    v_pk_add_u16 v18, v18, -1
    v_pk_add_u16 v19, v19, -1
    v_pk_ashrrev_i16 v16, 15, v16 op_sel_hi:[0,1]
    v_pk_ashrrev_i16 v17, 15, v17 op_sel_hi:[0,1]
    v_pk_ashrrev_i16 v18, 15, v18 op_sel_hi:[0,1]
    v_pk_ashrrev_i16 v19, 15, v19 op_sel_hi:[0,1]
    v_and_b32_dpp v20, v33, v16 row_newbcast:12 row_mask:0xf bank_mask:0xf
    v_and_b32_dpp v21, v33, v17 row_newbcast:13 row_mask:0xf bank_mask:0xf
    v_and_b32_dpp v22, v33, v18 row_newbcast:14 row_mask:0xf bank_mask:0xf
    v_and_b32_dpp v23, v33, v19 row_newbcast:15 row_mask:0xf bank_mask:0xf
    v_and_b32_dpp v24, v34, v16 row_newbcast:12 row_mask:0xf bank_mask:0xf
    v_and_b32_dpp v25, v34, v17 row_newbcast:13 row_mask:0xf bank_mask:0xf
    v_and_b32_dpp v26, v34, v18 row_newbcast:14 row_mask:0xf bank_mask:0xf
    v_and_b32_dpp v27, v34, v19 row_newbcast:15 row_mask:0xf bank_mask:0xf
    s_waitcnt lgkmcnt(0)
    v_mfma_f32_16x16x32_bf16 v[80:83], v[28:31], v[20:23], v[80:83]
    v_mfma_f32_16x16x32_bf16 v[84:87], v[28:31], v[24:27], v[84:87]
    v_and_b32_dpp v20, v35, v16 row_newbcast:12 row_mask:0xf bank_mask:0xf
    v_and_b32_dpp v21, v35, v17 row_newbcast:13 row_mask:0xf bank_mask:0xf
    v_and_b32_dpp v22, v35, v18 row_newbcast:14 row_mask:0xf bank_mask:0xf
    v_and_b32_dpp v23, v35, v19 row_newbcast:15 row_mask:0xf bank_mask:0xf
    s_nop 1
    v_mfma_f32_16x16x32_bf16 v[88:91], v[28:31], v[20:23], v[88:91]
    v_mul_f32 v20, 0.15915494, v63
    v_mul_f32 v21, 0.15915494, v67
    v_mul_f32 v22, 0x40400000, v63
    v_mul_f32 v23, 0x40400000, v67
    v_perm_b32 v26, v13, v12, s48
    v_cvt_pk_bf16_f32 v22, 0, v22
    v_cvt_pk_bf16_f32 v23, 0, v23
    v_cos_f32 v20, v20
    v_cos_f32 v21, v21
    v_mul_f32 v22, 0.15915494, v22
    v_mul_f32 v23, 0.15915494, v23
    v_pk_lshrrev_b16 v26, 5, v26 op_sel_hi:[0,1]
    v_cos_f32 v22, v22
    v_cos_f32 v23, v23
    v_add_f32 v24, v20, v20
    v_add_f32 v25, v21, v21
    v_and_b32 v32, s47, v26
    v_fma_f32 v24, v24, v20, -1.0
    v_fma_f32 v25, v25, v21, -1.0
    v_cvt_pk_bf16_f32 v33, v20, v21
    v_cvt_pk_bf16_f32 v35, v22, v23
    v_cvt_pk_bf16_f32 v34, v24, v25
    s_sub_u32 s41, s41, 1
    s_cbranch_scc1 L_en2_0__20
    s_branch L_bd1_0__36
L_bd2_0__40:
    s_waitcnt lgkmcnt(0)
    s_add_u32 m0, s49, 2048
    v_and_or_b32 v55, v55, s53, v6
    v_and_or_b32 v59, v59, s53, v6
    buffer_load_dwordx4 v55, s[4:7], 0 idxen lds
    s_add_u32 m0, s49, 3072
    s_add_u32 s50, s63, 1
    buffer_load_dwordx4 v59, s[4:7], 0 idxen lds
    v_readlane_b32 s51, v43, s63
    v_readlane_b32 s50, v43, s50
    s_add_u32 s63, s63, 2
    v_add_u32 v55, s51, v15
    v_add_u32 v59, s50, v15
    ds_read_b32 v55, v55
    ds_read_b32 v59, v59
    ds_bpermute_b32 v63, v51, v43
    v_add_u32 v51, 16, v51
    s_waitcnt vmcnt(2)
    ds_read_b64_tr_b16 v[28:29], v7 offset:0
    ds_read_b64_tr_b16 v[30:31], v8 offset:0
    v_xor_b32_dpp v16, v32, v14 row_newbcast:0 row_mask:0xf bank_mask:0xf
    v_xor_b32_dpp v17, v32, v14 row_newbcast:1 row_mask:0xf bank_mask:0xf
    v_xor_b32_dpp v18, v32, v14 row_newbcast:2 row_mask:0xf bank_mask:0xf
    v_xor_b32_dpp v19, v32, v14 row_newbcast:3 row_mask:0xf bank_mask:0xf
    v_pk_add_u16 v16, v16, -1
    v_pk_add_u16 v17, v17, -1
    v_pk_add_u16 v18, v18, -1
    v_pk_add_u16 v19, v19, -1
    v_pk_ashrrev_i16 v16, 15, v16 op_sel_hi:[0,1]
    v_pk_ashrrev_i16 v17, 15, v17 op_sel_hi:[0,1]
    v_pk_ashrrev_i16 v18, 15, v18 op_sel_hi:[0,1]
    v_pk_ashrrev_i16 v19, 15, v19 op_sel_hi:[0,1]
    v_and_b32_dpp v20, v33, v16 row_newbcast:0 row_mask:0xf bank_mask:0xf
    v_and_b32_dpp v21, v33, v17 row_newbcast:1 row_mask:0xf bank_mask:0xf
    v_and_b32_dpp v22, v33, v18 row_newbcast:2 row_mask:0xf bank_mask:0xf
    v_and_b32_dpp v23, v33, v19 row_newbcast:3 row_mask:0xf bank_mask:0xf
    v_and_b32_dpp v24, v34, v16 row_newbcast:0 row_mask:0xf bank_mask:0xf
    v_and_b32_dpp v25, v34, v17 row_newbcast:1 row_mask:0xf bank_mask:0xf
    v_and_b32_dpp v26, v34, v18 row_newbcast:2 row_mask:0xf bank_mask:0xf
    v_and_b32_dpp v27, v34, v19 row_newbcast:3 row_mask:0xf bank_mask:0xf
    s_waitcnt lgkmcnt(0)
    v_mfma_f32_16x16x32_bf16 v[92:95], v[28:31], v[20:23], v[92:95]
    v_mfma_f32_16x16x32_bf16 v[96:99], v[28:31], v[24:27], v[96:99]
    v_and_b32_dpp v20, v35, v16 row_newbcast:0 row_mask:0xf bank_mask:0xf
    v_and_b32_dpp v21, v35, v17 row_newbcast:1 row_mask:0xf bank_mask:0xf
    v_and_b32_dpp v22, v35, v18 row_newbcast:2 row_mask:0xf bank_mask:0xf
    v_and_b32_dpp v23, v35, v19 row_newbcast:3 row_mask:0xf bank_mask:0xf
    s_nop 1
    v_mfma_f32_16x16x32_bf16 v[100:103], v[28:31], v[20:23], v[100:103]
    s_sub_u32 s41, s41, 1
    s_cbranch_scc1 L_en3_1__25
L_bd2_1__41:
    ds_read_b64_tr_b16 v[28:29], v7 offset:1024
    ds_read_b64_tr_b16 v[30:31], v8 offset:1024
    v_add_u32 v63, v63, v1
    v_lshrrev_b32 v67, 1, v63
    ds_read_b64 v[12:13], v63
    ds_read_u16_d16_hi v63, v67 offset:47488
    ds_read_u16_d16_hi v67, v67 offset:47490
    v_xor_b32_dpp v16, v32, v14 row_newbcast:4 row_mask:0xf bank_mask:0xf
    v_xor_b32_dpp v17, v32, v14 row_newbcast:5 row_mask:0xf bank_mask:0xf
    v_xor_b32_dpp v18, v32, v14 row_newbcast:6 row_mask:0xf bank_mask:0xf
    v_xor_b32_dpp v19, v32, v14 row_newbcast:7 row_mask:0xf bank_mask:0xf
    v_pk_add_u16 v16, v16, -1
    v_pk_add_u16 v17, v17, -1
    v_pk_add_u16 v18, v18, -1
    v_pk_add_u16 v19, v19, -1
    v_pk_ashrrev_i16 v16, 15, v16 op_sel_hi:[0,1]
    v_pk_ashrrev_i16 v17, 15, v17 op_sel_hi:[0,1]
    v_pk_ashrrev_i16 v18, 15, v18 op_sel_hi:[0,1]
    v_pk_ashrrev_i16 v19, 15, v19 op_sel_hi:[0,1]
    v_and_b32_dpp v20, v33, v16 row_newbcast:4 row_mask:0xf bank_mask:0xf
    v_and_b32_dpp v21, v33, v17 row_newbcast:5 row_mask:0xf bank_mask:0xf
    v_and_b32_dpp v22, v33, v18 row_newbcast:6 row_mask:0xf bank_mask:0xf
    v_and_b32_dpp v23, v33, v19 row_newbcast:7 row_mask:0xf bank_mask:0xf
    v_and_b32_dpp v24, v34, v16 row_newbcast:4 row_mask:0xf bank_mask:0xf
    v_and_b32_dpp v25, v34, v17 row_newbcast:5 row_mask:0xf bank_mask:0xf
    v_and_b32_dpp v26, v34, v18 row_newbcast:6 row_mask:0xf bank_mask:0xf
    v_and_b32_dpp v27, v34, v19 row_newbcast:7 row_mask:0xf bank_mask:0xf
    s_waitcnt lgkmcnt(0)
    v_mfma_f32_16x16x32_bf16 v[92:95], v[28:31], v[20:23], v[92:95]
    v_mfma_f32_16x16x32_bf16 v[96:99], v[28:31], v[24:27], v[96:99]
    v_and_b32_dpp v20, v35, v16 row_newbcast:4 row_mask:0xf bank_mask:0xf
    v_and_b32_dpp v21, v35, v17 row_newbcast:5 row_mask:0xf bank_mask:0xf
    v_and_b32_dpp v22, v35, v18 row_newbcast:6 row_mask:0xf bank_mask:0xf
    v_and_b32_dpp v23, v35, v19 row_newbcast:7 row_mask:0xf bank_mask:0xf
    s_nop 1
    v_mfma_f32_16x16x32_bf16 v[100:103], v[28:31], v[20:23], v[100:103]
    s_sub_u32 s41, s41, 1
    s_cbranch_scc1 L_en3_2__26
L_bd2_2__42:
    s_add_u32 m0, s49, 0
    v_and_or_b32 v55, v55, s53, v6
    v_and_or_b32 v59, v59, s53, v6
    buffer_load_dwordx4 v55, s[4:7], 0 idxen lds
    s_add_u32 m0, s49, 1024
    s_add_u32 s50, s63, 1
    buffer_load_dwordx4 v59, s[4:7], 0 idxen lds
    v_readlane_b32 s51, v43, s63
    v_readlane_b32 s50, v43, s50
    s_add_u32 s63, s63, 2
    v_add_u32 v55, s51, v15
    v_add_u32 v59, s50, v15
    ds_read_b32 v55, v55
    ds_read_b32 v59, v59
    s_waitcnt vmcnt(2)
    ds_read_b64_tr_b16 v[28:29], v7 offset:2048
    ds_read_b64_tr_b16 v[30:31], v8 offset:2048
    v_xor_b32_dpp v16, v32, v14 row_newbcast:8 row_mask:0xf bank_mask:0xf
    v_xor_b32_dpp v17, v32, v14 row_newbcast:9 row_mask:0xf bank_mask:0xf
    v_xor_b32_dpp v18, v32, v14 row_newbcast:10 row_mask:0xf bank_mask:0xf
    v_xor_b32_dpp v19, v32, v14 row_newbcast:11 row_mask:0xf bank_mask:0xf
    v_pk_add_u16 v16, v16, -1
    v_pk_add_u16 v17, v17, -1
    v_pk_add_u16 v18, v18, -1
    v_pk_add_u16 v19, v19, -1
    v_pk_ashrrev_i16 v16, 15, v16 op_sel_hi:[0,1]
    v_pk_ashrrev_i16 v17, 15, v17 op_sel_hi:[0,1]
    v_pk_ashrrev_i16 v18, 15, v18 op_sel_hi:[0,1]
    v_pk_ashrrev_i16 v19, 15, v19 op_sel_hi:[0,1]
    v_and_b32_dpp v20, v33, v16 row_newbcast:8 row_mask:0xf bank_mask:0xf
    v_and_b32_dpp v21, v33, v17 row_newbcast:9 row_mask:0xf bank_mask:0xf
    v_and_b32_dpp v22, v33, v18 row_newbcast:10 row_mask:0xf bank_mask:0xf
    v_and_b32_dpp v23, v33, v19 row_newbcast:11 row_mask:0xf bank_mask:0xf
    v_and_b32_dpp v24, v34, v16 row_newbcast:8 row_mask:0xf bank_mask:0xf
    v_and_b32_dpp v25, v34, v17 row_newbcast:9 row_mask:0xf bank_mask:0xf
    v_and_b32_dpp v26, v34, v18 row_newbcast:10 row_mask:0xf bank_mask:0xf
    v_and_b32_dpp v27, v34, v19 row_newbcast:11 row_mask:0xf bank_mask:0xf
    s_waitcnt lgkmcnt(0)
    v_mfma_f32_16x16x32_bf16 v[92:95], v[28:31], v[20:23], v[92:95]
    v_mfma_f32_16x16x32_bf16 v[96:99], v[28:31], v[24:27], v[96:99]
    v_and_b32_dpp v20, v35, v16 row_newbcast:8 row_mask:0xf bank_mask:0xf
    v_and_b32_dpp v21, v35, v17 row_newbcast:9 row_mask:0xf bank_mask:0xf
    v_and_b32_dpp v22, v35, v18 row_newbcast:10 row_mask:0xf bank_mask:0xf
    v_and_b32_dpp v23, v35, v19 row_newbcast:11 row_mask:0xf bank_mask:0xf
    s_nop 1
    v_mfma_f32_16x16x32_bf16 v[100:103], v[28:31], v[20:23], v[100:103]
    s_sub_u32 s41, s41, 1
    s_cbranch_scc1 L_en3_3__27
L_bd2_3__43:
    ds_read_b64_tr_b16 v[28:29], v7 offset:3072
    ds_read_b64_tr_b16 v[30:31], v8 offset:3072
    v_xor_b32_dpp v16, v32, v14 row_newbcast:12 row_mask:0xf bank_mask:0xf
    v_xor_b32_dpp v17, v32, v14 row_newbcast:13 row_mask:0xf bank_mask:0xf
    v_xor_b32_dpp v18, v32, v14 row_newbcast:14 row_mask:0xf bank_mask:0xf
    v_xor_b32_dpp v19, v32, v14 row_newbcast:15 row_mask:0xf bank_mask:0xf
    v_pk_add_u16 v16, v16, -1
    v_pk_add_u16 v17, v17, -1
    v_pk_add_u16 v18, v18, -1
    v_pk_add_u16 v19, v19, -1
    v_pk_ashrrev_i16 v16, 15, v16 op_sel_hi:[0,1]
    v_pk_ashrrev_i16 v17, 15, v17 op_sel_hi:[0,1]
    v_pk_ashrrev_i16 v18, 15, v18 op_sel_hi:[0,1]
    v_pk_ashrrev_i16 v19, 15, v19 op_sel_hi:[0,1]
    v_and_b32_dpp v20, v33, v16 row_newbcast:12 row_mask:0xf bank_mask:0xf
    v_and_b32_dpp v21, v33, v17 row_newbcast:13 row_mask:0xf bank_mask:0xf
    v_and_b32_dpp v22, v33, v18 row_newbcast:14 row_mask:0xf bank_mask:0xf
    v_and_b32_dpp v23, v33, v19 row_newbcast:15 row_mask:0xf bank_mask:0xf
    v_and_b32_dpp v24, v34, v16 row_newbcast:12 row_mask:0xf bank_mask:0xf
    v_and_b32_dpp v25, v34, v17 row_newbcast:13 row_mask:0xf bank_mask:0xf
    v_and_b32_dpp v26, v34, v18 row_newbcast:14 row_mask:0xf bank_mask:0xf
    v_and_b32_dpp v27, v34, v19 row_newbcast:15 row_mask:0xf bank_mask:0xf
    s_waitcnt lgkmcnt(0)
    v_mfma_f32_16x16x32_bf16 v[92:95], v[28:31], v[20:23], v[92:95]
    v_mfma_f32_16x16x32_bf16 v[96:99], v[28:31], v[24:27], v[96:99]
    v_and_b32_dpp v20, v35, v16 row_newbcast:12 row_mask:0xf bank_mask:0xf
    v_and_b32_dpp v21, v35, v17 row_newbcast:13 row_mask:0xf bank_mask:0xf
    v_and_b32_dpp v22, v35, v18 row_newbcast:14 row_mask:0xf bank_mask:0xf
    v_and_b32_dpp v23, v35, v19 row_newbcast:15 row_mask:0xf bank_mask:0xf
    s_nop 1
    v_mfma_f32_16x16x32_bf16 v[100:103], v[28:31], v[20:23], v[100:103]
    v_mul_f32 v20, 0.15915494, v63
    v_mul_f32 v21, 0.15915494, v67
    v_mul_f32 v22, 0x40400000, v63
    v_mul_f32 v23, 0x40400000, v67
    v_perm_b32 v26, v13, v12, s48
    v_cvt_pk_bf16_f32 v22, 0, v22
    v_cvt_pk_bf16_f32 v23, 0, v23
    v_cos_f32 v20, v20
    v_cos_f32 v21, v21
    v_mul_f32 v22, 0.15915494, v22
    v_mul_f32 v23, 0.15915494, v23
    v_pk_lshrrev_b16 v26, 5, v26 op_sel_hi:[0,1]
    v_cos_f32 v22, v22
    v_cos_f32 v23, v23
    v_add_f32 v24, v20, v20
    v_add_f32 v25, v21, v21
    v_and_b32 v32, s47, v26
    v_fma_f32 v24, v24, v20, -1.0
    v_fma_f32 v25, v25, v21, -1.0
    v_cvt_pk_bf16_f32 v33, v20, v21
    v_cvt_pk_bf16_f32 v35, v22, v23
    v_cvt_pk_bf16_f32 v34, v24, v25
    s_sub_u32 s41, s41, 1
    s_cbranch_scc1 L_en3_0__24
    s_branch L_bd2_0__40
L_bd3_0__44:
    s_waitcnt lgkmcnt(0)
    s_add_u32 m0, s49, 2048
    v_and_or_b32 v55, v55, s53, v6
    v_and_or_b32 v59, v59, s53, v6
    buffer_load_dwordx4 v55, s[4:7], 0 idxen lds
    s_add_u32 m0, s49, 3072
    s_add_u32 s50, s63, 1
    buffer_load_dwordx4 v59, s[4:7], 0 idxen lds
    v_readlane_b32 s51, v43, s63
    v_readlane_b32 s50, v43, s50
    s_add_u32 s63, s63, 2
    v_add_u32 v55, s51, v15
    v_add_u32 v59, s50, v15
    ds_read_b32 v55, v55
    ds_read_b32 v59, v59
    ds_bpermute_b32 v63, v51, v43
    v_add_u32 v51, 16, v51
    s_waitcnt vmcnt(2)
    ds_read_b64_tr_b16 v[28:29], v7 offset:0
    ds_read_b64_tr_b16 v[30:31], v8 offset:0
    v_xor_b32_dpp v16, v32, v14 row_newbcast:0 row_mask:0xf bank_mask:0xf
    v_xor_b32_dpp v17, v32, v14 row_newbcast:1 row_mask:0xf bank_mask:0xf
    v_xor_b32_dpp v18, v32, v14 row_newbcast:2 row_mask:0xf bank_mask:0xf
    v_xor_b32_dpp v19, v32, v14 row_newbcast:3 row_mask:0xf bank_mask:0xf
    v_pk_add_u16 v16, v16, -1
    v_pk_add_u16 v17, v17, -1
    v_pk_add_u16 v18, v18, -1
    v_pk_add_u16 v19, v19, -1
    v_pk_ashrrev_i16 v16, 15, v16 op_sel_hi:[0,1]
    v_pk_ashrrev_i16 v17, 15, v17 op_sel_hi:[0,1]
    v_pk_ashrrev_i16 v18, 15, v18 op_sel_hi:[0,1]
    v_pk_ashrrev_i16 v19, 15, v19 op_sel_hi:[0,1]
    v_and_b32_dpp v20, v33, v16 row_newbcast:0 row_mask:0xf bank_mask:0xf
    v_and_b32_dpp v21, v33, v17 row_newbcast:1 row_mask:0xf bank_mask:0xf
    v_and_b32_dpp v22, v33, v18 row_newbcast:2 row_mask:0xf bank_mask:0xf
    v_and_b32_dpp v23, v33, v19 row_newbcast:3 row_mask:0xf bank_mask:0xf
    v_and_b32_dpp v24, v34, v16 row_newbcast:0 row_mask:0xf bank_mask:0xf
    v_and_b32_dpp v25, v34, v17 row_newbcast:1 row_mask:0xf bank_mask:0xf
    v_and_b32_dpp v26, v34, v18 row_newbcast:2 row_mask:0xf bank_mask:0xf
    v_and_b32_dpp v27, v34, v19 row_newbcast:3 row_mask:0xf bank_mask:0xf
    s_waitcnt lgkmcnt(0)
    v_mfma_f32_16x16x32_bf16 v[104:107], v[28:31], v[20:23], v[104:107]
    v_mfma_f32_16x16x32_bf16 v[108:111], v[28:31], v[24:27], v[108:111]
    v_and_b32_dpp v20, v35, v16 row_newbcast:0 row_mask:0xf bank_mask:0xf
    v_and_b32_dpp v21, v35, v17 row_newbcast:1 row_mask:0xf bank_mask:0xf
    v_and_b32_dpp v22, v35, v18 row_newbcast:2 row_mask:0xf bank_mask:0xf
    v_and_b32_dpp v23, v35, v19 row_newbcast:3 row_mask:0xf bank_mask:0xf
    s_nop 1
    v_mfma_f32_16x16x32_bf16 v[112:115], v[28:31], v[20:23], v[112:115]
    s_sub_u32 s41, s41, 1
    s_cbranch_scc1 L_en4_1__29
L_bd3_1__45:
    ds_read_b64_tr_b16 v[28:29], v7 offset:1024
    ds_read_b64_tr_b16 v[30:31], v8 offset:1024
    v_add_u32 v63, v63, v1
    v_lshrrev_b32 v67, 1, v63
    ds_read_b64 v[12:13], v63
    ds_read_u16_d16_hi v63, v67 offset:47488
    ds_read_u16_d16_hi v67, v67 offset:47490
    v_xor_b32_dpp v16, v32, v14 row_newbcast:4 row_mask:0xf bank_mask:0xf
    v_xor_b32_dpp v17, v32, v14 row_newbcast:5 row_mask:0xf bank_mask:0xf
    v_xor_b32_dpp v18, v32, v14 row_newbcast:6 row_mask:0xf bank_mask:0xf
    v_xor_b32_dpp v19, v32, v14 row_newbcast:7 row_mask:0xf bank_mask:0xf
    v_pk_add_u16 v16, v16, -1
    v_pk_add_u16 v17, v17, -1
    v_pk_add_u16 v18, v18, -1
    v_pk_add_u16 v19, v19, -1
    v_pk_ashrrev_i16 v16, 15, v16 op_sel_hi:[0,1]
    v_pk_ashrrev_i16 v17, 15, v17 op_sel_hi:[0,1]
    v_pk_ashrrev_i16 v18, 15, v18 op_sel_hi:[0,1]
    v_pk_ashrrev_i16 v19, 15, v19 op_sel_hi:[0,1]
    v_and_b32_dpp v20, v33, v16 row_newbcast:4 row_mask:0xf bank_mask:0xf
    v_and_b32_dpp v21, v33, v17 row_newbcast:5 row_mask:0xf bank_mask:0xf
    v_and_b32_dpp v22, v33, v18 row_newbcast:6 row_mask:0xf bank_mask:0xf
    v_and_b32_dpp v23, v33, v19 row_newbcast:7 row_mask:0xf bank_mask:0xf
    v_and_b32_dpp v24, v34, v16 row_newbcast:4 row_mask:0xf bank_mask:0xf
    v_and_b32_dpp v25, v34, v17 row_newbcast:5 row_mask:0xf bank_mask:0xf
    v_and_b32_dpp v26, v34, v18 row_newbcast:6 row_mask:0xf bank_mask:0xf
    v_and_b32_dpp v27, v34, v19 row_newbcast:7 row_mask:0xf bank_mask:0xf
    s_waitcnt lgkmcnt(0)
    v_mfma_f32_16x16x32_bf16 v[104:107], v[28:31], v[20:23], v[104:107]
    v_mfma_f32_16x16x32_bf16 v[108:111], v[28:31], v[24:27], v[108:111]
    v_and_b32_dpp v20, v35, v16 row_newbcast:4 row_mask:0xf bank_mask:0xf
    v_and_b32_dpp v21, v35, v17 row_newbcast:5 row_mask:0xf bank_mask:0xf
    v_and_b32_dpp v22, v35, v18 row_newbcast:6 row_mask:0xf bank_mask:0xf
    v_and_b32_dpp v23, v35, v19 row_newbcast:7 row_mask:0xf bank_mask:0xf
    s_nop 1
    v_mfma_f32_16x16x32_bf16 v[112:115], v[28:31], v[20:23], v[112:115]
    s_sub_u32 s41, s41, 1
    s_cbranch_scc1 L_en4_2__30
L_bd3_2__46:
    s_add_u32 m0, s49, 0
    v_and_or_b32 v55, v55, s53, v6
    v_and_or_b32 v59, v59, s53, v6
    buffer_load_dwordx4 v55, s[4:7], 0 idxen lds
    s_add_u32 m0, s49, 1024
    s_add_u32 s50, s63, 1
    buffer_load_dwordx4 v59, s[4:7], 0 idxen lds
    v_readlane_b32 s51, v43, s63
    v_readlane_b32 s50, v43, s50
    s_add_u32 s63, s63, 2
    v_add_u32 v55, s51, v15
    v_add_u32 v59, s50, v15
    ds_read_b32 v55, v55
    ds_read_b32 v59, v59
    s_waitcnt vmcnt(2)
    ds_read_b64_tr_b16 v[28:29], v7 offset:2048
    ds_read_b64_tr_b16 v[30:31], v8 offset:2048
    v_xor_b32_dpp v16, v32, v14 row_newbcast:8 row_mask:0xf bank_mask:0xf
    v_xor_b32_dpp v17, v32, v14 row_newbcast:9 row_mask:0xf bank_mask:0xf
    v_xor_b32_dpp v18, v32, v14 row_newbcast:10 row_mask:0xf bank_mask:0xf
    v_xor_b32_dpp v19, v32, v14 row_newbcast:11 row_mask:0xf bank_mask:0xf
    v_pk_add_u16 v16, v16, -1
    v_pk_add_u16 v17, v17, -1
    v_pk_add_u16 v18, v18, -1
    v_pk_add_u16 v19, v19, -1
    v_pk_ashrrev_i16 v16, 15, v16 op_sel_hi:[0,1]
    v_pk_ashrrev_i16 v17, 15, v17 op_sel_hi:[0,1]
    v_pk_ashrrev_i16 v18, 15, v18 op_sel_hi:[0,1]
    v_pk_ashrrev_i16 v19, 15, v19 op_sel_hi:[0,1]
    v_and_b32_dpp v20, v33, v16 row_newbcast:8 row_mask:0xf bank_mask:0xf
    v_and_b32_dpp v21, v33, v17 row_newbcast:9 row_mask:0xf bank_mask:0xf
    v_and_b32_dpp v22, v33, v18 row_newbcast:10 row_mask:0xf bank_mask:0xf
    v_and_b32_dpp v23, v33, v19 row_newbcast:11 row_mask:0xf bank_mask:0xf
    v_and_b32_dpp v24, v34, v16 row_newbcast:8 row_mask:0xf bank_mask:0xf
    v_and_b32_dpp v25, v34, v17 row_newbcast:9 row_mask:0xf bank_mask:0xf
    v_and_b32_dpp v26, v34, v18 row_newbcast:10 row_mask:0xf bank_mask:0xf
    v_and_b32_dpp v27, v34, v19 row_newbcast:11 row_mask:0xf bank_mask:0xf
    s_waitcnt lgkmcnt(0)
    v_mfma_f32_16x16x32_bf16 v[104:107], v[28:31], v[20:23], v[104:107]
    v_mfma_f32_16x16x32_bf16 v[108:111], v[28:31], v[24:27], v[108:111]
    v_and_b32_dpp v20, v35, v16 row_newbcast:8 row_mask:0xf bank_mask:0xf
    v_and_b32_dpp v21, v35, v17 row_newbcast:9 row_mask:0xf bank_mask:0xf
    v_and_b32_dpp v22, v35, v18 row_newbcast:10 row_mask:0xf bank_mask:0xf
    v_and_b32_dpp v23, v35, v19 row_newbcast:11 row_mask:0xf bank_mask:0xf
    s_nop 1
    v_mfma_f32_16x16x32_bf16 v[112:115], v[28:31], v[20:23], v[112:115]
    s_sub_u32 s41, s41, 1
    s_cbranch_scc1 L_en4_3__31
L_bd3_3__47:
    ds_read_b64_tr_b16 v[28:29], v7 offset:3072
    ds_read_b64_tr_b16 v[30:31], v8 offset:3072
    v_xor_b32_dpp v16, v32, v14 row_newbcast:12 row_mask:0xf bank_mask:0xf
    v_xor_b32_dpp v17, v32, v14 row_newbcast:13 row_mask:0xf bank_mask:0xf
    v_xor_b32_dpp v18, v32, v14 row_newbcast:14 row_mask:0xf bank_mask:0xf
    v_xor_b32_dpp v19, v32, v14 row_newbcast:15 row_mask:0xf bank_mask:0xf
    v_pk_add_u16 v16, v16, -1
    v_pk_add_u16 v17, v17, -1
    v_pk_add_u16 v18, v18, -1
    v_pk_add_u16 v19, v19, -1
    v_pk_ashrrev_i16 v16, 15, v16 op_sel_hi:[0,1]
    v_pk_ashrrev_i16 v17, 15, v17 op_sel_hi:[0,1]
    v_pk_ashrrev_i16 v18, 15, v18 op_sel_hi:[0,1]
    v_pk_ashrrev_i16 v19, 15, v19 op_sel_hi:[0,1]
    v_and_b32_dpp v20, v33, v16 row_newbcast:12 row_mask:0xf bank_mask:0xf
    v_and_b32_dpp v21, v33, v17 row_newbcast:13 row_mask:0xf bank_mask:0xf
    v_and_b32_dpp v22, v33, v18 row_newbcast:14 row_mask:0xf bank_mask:0xf
    v_and_b32_dpp v23, v33, v19 row_newbcast:15 row_mask:0xf bank_mask:0xf
    v_and_b32_dpp v24, v34, v16 row_newbcast:12 row_mask:0xf bank_mask:0xf
    v_and_b32_dpp v25, v34, v17 row_newbcast:13 row_mask:0xf bank_mask:0xf
    v_and_b32_dpp v26, v34, v18 row_newbcast:14 row_mask:0xf bank_mask:0xf
    v_and_b32_dpp v27, v34, v19 row_newbcast:15 row_mask:0xf bank_mask:0xf
    s_waitcnt lgkmcnt(0)
    v_mfma_f32_16x16x32_bf16 v[104:107], v[28:31], v[20:23], v[104:107]
    v_mfma_f32_16x16x32_bf16 v[108:111], v[28:31], v[24:27], v[108:111]
    v_and_b32_dpp v20, v35, v16 row_newbcast:12 row_mask:0xf bank_mask:0xf
    v_and_b32_dpp v21, v35, v17 row_newbcast:13 row_mask:0xf bank_mask:0xf
    v_and_b32_dpp v22, v35, v18 row_newbcast:14 row_mask:0xf bank_mask:0xf
    v_and_b32_dpp v23, v35, v19 row_newbcast:15 row_mask:0xf bank_mask:0xf
    s_nop 1
    v_mfma_f32_16x16x32_bf16 v[112:115], v[28:31], v[20:23], v[112:115]
    v_mul_f32 v20, 0.15915494, v63
    v_mul_f32 v21, 0.15915494, v67
    v_mul_f32 v22, 0x40400000, v63
    v_mul_f32 v23, 0x40400000, v67
    v_perm_b32 v26, v13, v12, s48
    v_cvt_pk_bf16_f32 v22, 0, v22
    v_cvt_pk_bf16_f32 v23, 0, v23
    v_cos_f32 v20, v20
    v_cos_f32 v21, v21
    v_mul_f32 v22, 0.15915494, v22
    v_mul_f32 v23, 0.15915494, v23
    v_pk_lshrrev_b16 v26, 5, v26 op_sel_hi:[0,1]
    v_cos_f32 v22, v22
    v_cos_f32 v23, v23
    v_add_f32 v24, v20, v20
    v_add_f32 v25, v21, v21
    v_and_b32 v32, s47, v26
    v_fma_f32 v24, v24, v20, -1.0
    v_fma_f32 v25, v25, v21, -1.0
    v_cvt_pk_bf16_f32 v33, v20, v21
    v_cvt_pk_bf16_f32 v35, v22, v23
    v_cvt_pk_bf16_f32 v34, v24, v25
    s_sub_u32 s41, s41, 1
    s_cbranch_scc1 L_en4_0__28
    s_branch L_bd3_0__44
L_bd4_0__48:
    s_waitcnt lgkmcnt(0)
    s_add_u32 m0, s49, 2048
    v_and_or_b32 v55, v55, s53, v6
    v_and_or_b32 v59, v59, s53, v6
    buffer_load_dwordx4 v55, s[4:7], 0 idxen lds
    s_add_u32 m0, s49, 3072
    s_add_u32 s50, s63, 1
    buffer_load_dwordx4 v59, s[4:7], 0 idxen lds
    v_readlane_b32 s51, v43, s63
    v_readlane_b32 s50, v43, s50
    s_add_u32 s63, s63, 2
    v_add_u32 v55, s51, v15
    v_add_u32 v59, s50, v15
    ds_read_b32 v55, v55
    ds_read_b32 v59, v59
    ds_bpermute_b32 v63, v51, v43
    v_add_u32 v51, 16, v51
    s_waitcnt vmcnt(2)
    ds_read_b64_tr_b16 v[28:29], v7 offset:0
    ds_read_b64_tr_b16 v[30:31], v8 offset:0
    v_xor_b32_dpp v16, v32, v14 row_newbcast:0 row_mask:0xf bank_mask:0xf
    v_xor_b32_dpp v17, v32, v14 row_newbcast:1 row_mask:0xf bank_mask:0xf
    v_xor_b32_dpp v18, v32, v14 row_newbcast:2 row_mask:0xf bank_mask:0xf
    v_xor_b32_dpp v19, v32, v14 row_newbcast:3 row_mask:0xf bank_mask:0xf
    v_pk_add_u16 v16, v16, -1
    v_pk_add_u16 v17, v17, -1
    v_pk_add_u16 v18, v18, -1
    v_pk_add_u16 v19, v19, -1
    v_pk_ashrrev_i16 v16, 15, v16 op_sel_hi:[0,1]
    v_pk_ashrrev_i16 v17, 15, v17 op_sel_hi:[0,1]
    v_pk_ashrrev_i16 v18, 15, v18 op_sel_hi:[0,1]
    v_pk_ashrrev_i16 v19, 15, v19 op_sel_hi:[0,1]
    v_and_b32_dpp v20, v33, v16 row_newbcast:0 row_mask:0xf bank_mask:0xf
    v_and_b32_dpp v21, v33, v17 row_newbcast:1 row_mask:0xf bank_mask:0xf
    v_and_b32_dpp v22, v33, v18 row_newbcast:2 row_mask:0xf bank_mask:0xf
    v_and_b32_dpp v23, v33, v19 row_newbcast:3 row_mask:0xf bank_mask:0xf
    v_and_b32_dpp v24, v34, v16 row_newbcast:0 row_mask:0xf bank_mask:0xf
    v_and_b32_dpp v25, v34, v17 row_newbcast:1 row_mask:0xf bank_mask:0xf
    v_and_b32_dpp v26, v34, v18 row_newbcast:2 row_mask:0xf bank_mask:0xf
    v_and_b32_dpp v27, v34, v19 row_newbcast:3 row_mask:0xf bank_mask:0xf
    s_waitcnt lgkmcnt(0)
    v_mfma_f32_16x16x32_bf16 v[116:119], v[28:31], v[20:23], v[116:119]
    v_mfma_f32_16x16x32_bf16 v[120:123], v[28:31], v[24:27], v[120:123]
    v_and_b32_dpp v20, v35, v16 row_newbcast:0 row_mask:0xf bank_mask:0xf
    v_and_b32_dpp v21, v35, v17 row_newbcast:1 row_mask:0xf bank_mask:0xf
    v_and_b32_dpp v22, v35, v18 row_newbcast:2 row_mask:0xf bank_mask:0xf
    v_and_b32_dpp v23, v35, v19 row_newbcast:3 row_mask:0xf bank_mask:0xf
    s_nop 1
    v_mfma_f32_16x16x32_bf16 v[124:127], v[28:31], v[20:23], v[124:127]
    s_sub_u32 s41, s41, 1
    s_cbranch_scc1 L_cend_8
L_bd4_1__49:
    ds_read_b64_tr_b16 v[28:29], v7 offset:1024
    ds_read_b64_tr_b16 v[30:31], v8 offset:1024
    v_add_u32 v63, v63, v1
    v_lshrrev_b32 v67, 1, v63
    ds_read_b64 v[12:13], v63
    ds_read_u16_d16_hi v63, v67 offset:47488
    ds_read_u16_d16_hi v67, v67 offset:47490
    v_xor_b32_dpp v16, v32, v14 row_newbcast:4 row_mask:0xf bank_mask:0xf
    v_xor_b32_dpp v17, v32, v14 row_newbcast:5 row_mask:0xf bank_mask:0xf
    v_xor_b32_dpp v18, v32, v14 row_newbcast:6 row_mask:0xf bank_mask:0xf
    v_xor_b32_dpp v19, v32, v14 row_newbcast:7 row_mask:0xf bank_mask:0xf
    v_pk_add_u16 v16, v16, -1
    v_pk_add_u16 v17, v17, -1
    v_pk_add_u16 v18, v18, -1
    v_pk_add_u16 v19, v19, -1
    v_pk_ashrrev_i16 v16, 15, v16 op_sel_hi:[0,1]
    v_pk_ashrrev_i16 v17, 15, v17 op_sel_hi:[0,1]
    v_pk_ashrrev_i16 v18, 15, v18 op_sel_hi:[0,1]
    v_pk_ashrrev_i16 v19, 15, v19 op_sel_hi:[0,1]
    v_and_b32_dpp v20, v33, v16 row_newbcast:4 row_mask:0xf bank_mask:0xf
    v_and_b32_dpp v21, v33, v17 row_newbcast:5 row_mask:0xf bank_mask:0xf
    v_and_b32_dpp v22, v33, v18 row_newbcast:6 row_mask:0xf bank_mask:0xf
    v_and_b32_dpp v23, v33, v19 row_newbcast:7 row_mask:0xf bank_mask:0xf
    v_and_b32_dpp v24, v34, v16 row_newbcast:4 row_mask:0xf bank_mask:0xf
    v_and_b32_dpp v25, v34, v17 row_newbcast:5 row_mask:0xf bank_mask:0xf
    v_and_b32_dpp v26, v34, v18 row_newbcast:6 row_mask:0xf bank_mask:0xf
    v_and_b32_dpp v27, v34, v19 row_newbcast:7 row_mask:0xf bank_mask:0xf
    s_waitcnt lgkmcnt(0)
    v_mfma_f32_16x16x32_bf16 v[116:119], v[28:31], v[20:23], v[116:119]
    v_mfma_f32_16x16x32_bf16 v[120:123], v[28:31], v[24:27], v[120:123]
    v_and_b32_dpp v20, v35, v16 row_newbcast:4 row_mask:0xf bank_mask:0xf
    v_and_b32_dpp v21, v35, v17 row_newbcast:5 row_mask:0xf bank_mask:0xf
    v_and_b32_dpp v22, v35, v18 row_newbcast:6 row_mask:0xf bank_mask:0xf
    v_and_b32_dpp v23, v35, v19 row_newbcast:7 row_mask:0xf bank_mask:0xf
    s_nop 1
    v_mfma_f32_16x16x32_bf16 v[124:127], v[28:31], v[20:23], v[124:127]
    s_sub_u32 s41, s41, 1
    s_cbranch_scc1 L_cend_8
L_bd4_2__50:
    s_add_u32 m0, s49, 0
    v_and_or_b32 v55, v55, s53, v6
    v_and_or_b32 v59, v59, s53, v6
    buffer_load_dwordx4 v55, s[4:7], 0 idxen lds
    s_add_u32 m0, s49, 1024
    s_add_u32 s50, s63, 1
    buffer_load_dwordx4 v59, s[4:7], 0 idxen lds
    v_readlane_b32 s51, v43, s63
    v_readlane_b32 s50, v43, s50
    s_add_u32 s63, s63, 2
    v_add_u32 v55, s51, v15
    v_add_u32 v59, s50, v15
    ds_read_b32 v55, v55
    ds_read_b32 v59, v59
    s_waitcnt vmcnt(2)
    ds_read_b64_tr_b16 v[28:29], v7 offset:2048
    ds_read_b64_tr_b16 v[30:31], v8 offset:2048
    v_xor_b32_dpp v16, v32, v14 row_newbcast:8 row_mask:0xf bank_mask:0xf
    v_xor_b32_dpp v17, v32, v14 row_newbcast:9 row_mask:0xf bank_mask:0xf
    v_xor_b32_dpp v18, v32, v14 row_newbcast:10 row_mask:0xf bank_mask:0xf
    v_xor_b32_dpp v19, v32, v14 row_newbcast:11 row_mask:0xf bank_mask:0xf
    v_pk_add_u16 v16, v16, -1
    v_pk_add_u16 v17, v17, -1
    v_pk_add_u16 v18, v18, -1
    v_pk_add_u16 v19, v19, -1
    v_pk_ashrrev_i16 v16, 15, v16 op_sel_hi:[0,1]
    v_pk_ashrrev_i16 v17, 15, v17 op_sel_hi:[0,1]
    v_pk_ashrrev_i16 v18, 15, v18 op_sel_hi:[0,1]
    v_pk_ashrrev_i16 v19, 15, v19 op_sel_hi:[0,1]
    v_and_b32_dpp v20, v33, v16 row_newbcast:8 row_mask:0xf bank_mask:0xf
    v_and_b32_dpp v21, v33, v17 row_newbcast:9 row_mask:0xf bank_mask:0xf
    v_and_b32_dpp v22, v33, v18 row_newbcast:10 row_mask:0xf bank_mask:0xf
    v_and_b32_dpp v23, v33, v19 row_newbcast:11 row_mask:0xf bank_mask:0xf
    v_and_b32_dpp v24, v34, v16 row_newbcast:8 row_mask:0xf bank_mask:0xf
    v_and_b32_dpp v25, v34, v17 row_newbcast:9 row_mask:0xf bank_mask:0xf
    v_and_b32_dpp v26, v34, v18 row_newbcast:10 row_mask:0xf bank_mask:0xf
    v_and_b32_dpp v27, v34, v19 row_newbcast:11 row_mask:0xf bank_mask:0xf
    s_waitcnt lgkmcnt(0)
    v_mfma_f32_16x16x32_bf16 v[116:119], v[28:31], v[20:23], v[116:119]
    v_mfma_f32_16x16x32_bf16 v[120:123], v[28:31], v[24:27], v[120:123]
    v_and_b32_dpp v20, v35, v16 row_newbcast:8 row_mask:0xf bank_mask:0xf
    v_and_b32_dpp v21, v35, v17 row_newbcast:9 row_mask:0xf bank_mask:0xf
    v_and_b32_dpp v22, v35, v18 row_newbcast:10 row_mask:0xf bank_mask:0xf
    v_and_b32_dpp v23, v35, v19 row_newbcast:11 row_mask:0xf bank_mask:0xf
    s_nop 1
    v_mfma_f32_16x16x32_bf16 v[124:127], v[28:31], v[20:23], v[124:127]
    s_sub_u32 s41, s41, 1
    s_cbranch_scc1 L_cend_8
L_bd4_3__51:
    ds_read_b64_tr_b16 v[28:29], v7 offset:3072
    ds_read_b64_tr_b16 v[30:31], v8 offset:3072
    v_xor_b32_dpp v16, v32, v14 row_newbcast:12 row_mask:0xf bank_mask:0xf
    v_xor_b32_dpp v17, v32, v14 row_newbcast:13 row_mask:0xf bank_mask:0xf
    v_xor_b32_dpp v18, v32, v14 row_newbcast:14 row_mask:0xf bank_mask:0xf
    v_xor_b32_dpp v19, v32, v14 row_newbcast:15 row_mask:0xf bank_mask:0xf
    v_pk_add_u16 v16, v16, -1
    v_pk_add_u16 v17, v17, -1
    v_pk_add_u16 v18, v18, -1
    v_pk_add_u16 v19, v19, -1
    v_pk_ashrrev_i16 v16, 15, v16 op_sel_hi:[0,1]
    v_pk_ashrrev_i16 v17, 15, v17 op_sel_hi:[0,1]
    v_pk_ashrrev_i16 v18, 15, v18 op_sel_hi:[0,1]
    v_pk_ashrrev_i16 v19, 15, v19 op_sel_hi:[0,1]
    v_and_b32_dpp v20, v33, v16 row_newbcast:12 row_mask:0xf bank_mask:0xf
    v_and_b32_dpp v21, v33, v17 row_newbcast:13 row_mask:0xf bank_mask:0xf
    v_and_b32_dpp v22, v33, v18 row_newbcast:14 row_mask:0xf bank_mask:0xf
    v_and_b32_dpp v23, v33, v19 row_newbcast:15 row_mask:0xf bank_mask:0xf
    v_and_b32_dpp v24, v34, v16 row_newbcast:12 row_mask:0xf bank_mask:0xf
    v_and_b32_dpp v25, v34, v17 row_newbcast:13 row_mask:0xf bank_mask:0xf
    v_and_b32_dpp v26, v34, v18 row_newbcast:14 row_mask:0xf bank_mask:0xf
    v_and_b32_dpp v27, v34, v19 row_newbcast:15 row_mask:0xf bank_mask:0xf
    s_waitcnt lgkmcnt(0)
    v_mfma_f32_16x16x32_bf16 v[116:119], v[28:31], v[20:23], v[116:119]
    v_mfma_f32_16x16x32_bf16 v[120:123], v[28:31], v[24:27], v[120:123]
    v_and_b32_dpp v20, v35, v16 row_newbcast:12 row_mask:0xf bank_mask:0xf
    v_and_b32_dpp v21, v35, v17 row_newbcast:13 row_mask:0xf bank_mask:0xf
    v_and_b32_dpp v22, v35, v18 row_newbcast:14 row_mask:0xf bank_mask:0xf
    v_and_b32_dpp v23, v35, v19 row_newbcast:15 row_mask:0xf bank_mask:0xf
    s_nop 1
    v_mfma_f32_16x16x32_bf16 v[124:127], v[28:31], v[20:23], v[124:127]
    v_mul_f32 v20, 0.15915494, v63
    v_mul_f32 v21, 0.15915494, v67
    v_mul_f32 v22, 0x40400000, v63
    v_mul_f32 v23, 0x40400000, v67
    v_perm_b32 v26, v13, v12, s48
    v_cvt_pk_bf16_f32 v22, 0, v22
    v_cvt_pk_bf16_f32 v23, 0, v23
    v_cos_f32 v20, v20
    v_cos_f32 v21, v21
    v_mul_f32 v22, 0.15915494, v22
    v_mul_f32 v23, 0.15915494, v23
    v_pk_lshrrev_b16 v26, 5, v26 op_sel_hi:[0,1]
    v_cos_f32 v22, v22
    v_cos_f32 v23, v23
    v_add_f32 v24, v20, v20
    v_add_f32 v25, v21, v21
    v_and_b32 v32, s47, v26
    v_fma_f32 v24, v24, v20, -1.0
    v_fma_f32 v25, v25, v21, -1.0
    v_cvt_pk_bf16_f32 v33, v20, v21
    v_cvt_pk_bf16_f32 v35, v22, v23
    v_cvt_pk_bf16_f32 v34, v24, v25
    s_sub_u32 s41, s41, 1
    s_cbranch_scc1 L_cend_8
    s_branch L_bd4_0__48
L_en0_0__12:
    s_sub_u32 s41, s36, 1
    s_cbranch_scc0 L_bd0_0__32
    s_branch L_en1_0__16
L_en0_1__13:
    s_sub_u32 s41, s36, 1
    s_cbranch_scc0 L_bd0_1__33
    s_branch L_en1_1__17
L_en0_2__14:
    s_sub_u32 s41, s36, 1
    s_cbranch_scc0 L_bd0_2__34
    s_branch L_en1_2__18
L_en0_3__15:
    s_sub_u32 s41, s36, 1
    s_cbranch_scc0 L_bd0_3__35
    s_branch L_en1_3__19
L_en1_0__16:
    s_sub_u32 s41, s37, 1
    s_cbranch_scc0 L_bd1_0__36
    s_branch L_en2_0__20
L_en1_1__17:
    s_sub_u32 s41, s37, 1
    s_cbranch_scc0 L_bd1_1__37
    s_branch L_en2_1__21
L_en1_2__18:
    s_sub_u32 s41, s37, 1
    s_cbranch_scc0 L_bd1_2__38
    s_branch L_en2_2__22
L_en1_3__19:
    s_sub_u32 s41, s37, 1
    s_cbranch_scc0 L_bd1_3__39
    s_branch L_en2_3__23
L_en2_0__20:
    s_sub_u32 s41, s38, 1
    s_cbranch_scc0 L_bd2_0__40
    s_branch L_en3_0__24
L_en2_1__21:
    s_sub_u32 s41, s38, 1
    s_cbranch_scc0 L_bd2_1__41
    s_branch L_en3_1__25
L_en2_2__22:
    s_sub_u32 s41, s38, 1
    s_cbranch_scc0 L_bd2_2__42
    s_branch L_en3_2__26
L_en2_3__23:
    s_sub_u32 s41, s38, 1
    s_cbranch_scc0 L_bd2_3__43
    s_branch L_en3_3__27
L_en3_0__24:
    s_sub_u32 s41, s39, 1
    s_cbranch_scc0 L_bd3_0__44
    s_branch L_en4_0__28
L_en3_1__25:
    s_sub_u32 s41, s39, 1
    s_cbranch_scc0 L_bd3_1__45
    s_branch L_en4_1__29
L_en3_2__26:
    s_sub_u32 s41, s39, 1
    s_cbranch_scc0 L_bd3_2__46
    s_branch L_en4_2__30
L_en3_3__27:
    s_sub_u32 s41, s39, 1
    s_cbranch_scc0 L_bd3_3__47
    s_branch L_en4_3__31
L_en4_0__28:
    s_sub_u32 s41, s40, 1
    s_cbranch_scc0 L_bd4_0__48
    s_branch L_cend_8
L_en4_1__29:
    s_sub_u32 s41, s40, 1
    s_cbranch_scc0 L_bd4_1__49
    s_branch L_cend_8
L_en4_2__30:
    s_sub_u32 s41, s40, 1
    s_cbranch_scc0 L_bd4_2__50
    s_branch L_cend_8
L_en4_3__31:
    s_sub_u32 s41, s40, 1
    s_cbranch_scc0 L_bd4_3__51
    s_branch L_cend_8
L_cend_8:
    s_cmp_eq_u32 s57, 0
    s_cbranch_scc0 L_nomv_9
    v_and_b32 v16, 0xff, v11
    v_and_b32 v17, 0x7c, v16
    v_lshrrev_b32 v18, 7, v16
    v_add_u32 v18, s55, v18
    v_lshlrev_b32 v18, 2, v18
    ds_bpermute_b32 v20, v18, v0 offset:0
    ds_bpermute_b32 v21, v18, v0 offset:8
    ds_bpermute_b32 v22, v18, v0 offset:16
    s_waitcnt lgkmcnt(0)
    v_add_u32 v20, v20, v17
    v_lshrrev_b32 v24, 1, v20
    ds_read_b32 v43, v20 offset:33280
    ds_read_u16 v59, v24 offset:64128
    v_add_u32 v21, v21, v17
    v_lshrrev_b32 v25, 1, v21
    ds_read_b32 v51, v21 offset:33280
    ds_read_u16 v63, v25 offset:64128
    v_add_u32 v22, v22, v17
    v_lshrrev_b32 v26, 1, v22
    ds_read_b32 v55, v22 offset:33280
    ds_read_u16 v67, v26 offset:64128
    v_and_b32 v16, 0xff, v11
    v_and_b32 v17, 0x7c, v16
    v_lshrrev_b32 v19, 7, v16
    v_mul_u32_u24 v19, 768, v19
    v_add3_u32 v19, v19, s46, v17
    v_lshrrev_b32 v23, 1, v19
    v_add_u32 v23, 4096, v23
    s_waitcnt lgkmcnt(0)
    ds_write_b32 v19, v43 offset:33280
    ds_write_b16 v23, v59 offset:60032
    ds_write_b32 v19, v51 offset:34816
    ds_write_b16 v23, v63 offset:60800
    s_mov_b32 exec_hi, 0
    ds_write_b32 v19, v55 offset:36352
    ds_write_b16 v23, v67 offset:61568
    s_mov_b64 exec, -1
L_nomv_9:
L_p2_skipc:
    s_waitcnt lgkmcnt(0)
    s_barrier
    s_cmp_eq_u32 s19, 0
    s_cbranch_scc1 L_p2_slow
    s_mov_b32 s14, 1
    s_mov_b32 s15, 0
    s_mov_b32 s16, 0
    s_branch L_p2_round
L_p2_slow:
    s_cmp_eq_u32 s14, 0
    s_cbranch_scc1 L_p2_phdone
    s_cmp_eq_u32 s18, 0
    s_cbranch_scc1 L_p2_nextk
    s_add_u32 s16, s16, 1
    s_branch L_p2_round
L_p2_nextk:
    s_mov_b32 s16, 0
    s_add_u32 s15, s15, 1
    s_cmp_lt_u32 s15, 64
    s_cbranch_scc1 L_p2_round
L_p2_phdone:
    v_mov_b32 v2, v3
    v_mov_b32 v3, v4
    v_mov_b32 v4, v5
    v_mov_b32 v5, v9
    v_mov_b32 v9, 0
    s_add_u32 s13, s13, 1
    s_cmp_lt_u32 s13, 5
    s_cbranch_scc1 L_p2_phase
    s_waitcnt vmcnt(0)
    s_load_dwordx2 s[20:21], s[0:1], 72
    s_load_dwordx2 s[24:25], s[0:1], 80
    s_load_dwordx2 s[28:29], s[0:1], 56
    s_load_dwordx2 s[32:33], s[0:1], 64
    s_load_dwordx2 s[36:37], s[0:1], 24
    s_load_dwordx2 s[40:41], s[0:1], 40
    s_load_dwordx2 s[44:45], s[0:1], 88
    s_load_dwordx2 s[64:65], s[0:1], 0
    s_mov_b32 s22, 512
    s_mov_b32 s23, 0x00020000
    s_mov_b32 s26, 512
    s_mov_b32 s27, 0x00020000
    s_mov_b32 s30, 256
    s_mov_b32 s31, 0x00020000
    s_mov_b32 s34, 768
    s_mov_b32 s35, 0x00020000
    s_mov_b32 s38, 640000
    s_mov_b32 s39, 0x00020000
    s_mov_b32 s42, 16
    s_mov_b32 s43, 0x00020000
    s_mov_b32 s46, 10240000
    s_mov_b32 s47, 0x00020000
    s_mov_b32 s66, 10240000
    s_mov_b32 s67, 0x00020000
    v_mbcnt_lo_u32_b32 v21, -1, 0
    v_mbcnt_hi_u32_b32 v21, -1, v21
    v_and_b32 v22, 15, v21
    v_lshrrev_b32 v23, 4, v21
    v_lshlrev_b32 v24, 4, v21
    s_lshl_b32 s49, s12, 12
    s_waitcnt lgkmcnt(0)
    s_add_u32 m0, s49, 0
    s_nop 0
    buffer_load_dwordx4 v24, s[20:23], 0 offen lds
    s_add_u32 m0, s49, 1024
    s_nop 0
    buffer_load_dwordx4 v24, s[24:27], 0 offen lds
    s_add_u32 m0, s49, 2048
    s_nop 0
    buffer_load_dwordx4 v24, s[28:31], 0 offen lds
    s_add_u32 m0, s49, 3072
    s_nop 0
    buffer_load_dwordx4 v24, s[32:35], 0 offen lds
    v_and_b32 v25, 1, v23
    v_lshlrev_b32 v25, 3, v25
    buffer_load_dwordx2 v[26:27], v25, s[40:43], 0 offen
    s_mul_i32 s50, s56, 640
    s_mul_i32 s51, s12, 80
    s_add_u32 s50, s50, s51
    v_add_u32 v28, s50, v22
    v_lshlrev_b32 v29, 1, v28
    v_lshlrev_b32 v30, 5, v28
    v_lshl_add_u32 v30, v23, 3, v30
    buffer_load_ushort v31, v29, s[36:39], 0 offen offset:0
    buffer_load_dwordx2 v[36:37], v30, s[64:67], 0 offen offset:0
    buffer_load_ushort v32, v29, s[36:39], 0 offen offset:32
    buffer_load_dwordx2 v[38:39], v30, s[64:67], 0 offen offset:512
    buffer_load_ushort v33, v29, s[36:39], 0 offen offset:64
    buffer_load_dwordx2 v[40:41], v30, s[64:67], 0 offen offset:1024
    buffer_load_ushort v34, v29, s[36:39], 0 offen offset:96
    buffer_load_dwordx2 v[42:43], v30, s[64:67], 0 offen offset:1536
    buffer_load_ushort v35, v29, s[36:39], 0 offen offset:128
    buffer_load_dwordx2 v[44:45], v30, s[64:67], 0 offen offset:2048
    v_lshlrev_b32 v25, 3, v21
    v_add_u32 v25, s49, v25
    v_lshrrev_b32 v46, 2, v21
    v_mul_u32_u24 v46, 96, v46
    v_and_b32 v47, 3, v21
    v_lshl_add_u32 v46, v47, 3, v46
    v_min_u32 v46, 832, v46
    v_add_u32 v46, s49, v46
    s_waitcnt vmcnt(0)
    ds_read_b64_tr_b16 v[48:49], v25
    ds_read_b64_tr_b16 v[50:51], v25 offset:1024
    ds_read_b64_tr_b16 v[52:53], v25 offset:2048
    ds_read_b64_tr_b16 v[54:55], v46 offset:3072
    ds_read_b64_tr_b16 v[56:57], v46 offset:3104
    ds_read_b64_tr_b16 v[58:59], v46 offset:3136
    v_lshlrev_b32 v60, 16, v26
    v_and_b32 v61, 0xffff0000, v26
    v_lshlrev_b32 v62, 16, v27
    v_and_b32 v63, 0xffff0000, v27
    s_mov_b32 s62, 0xc1200000
    s_mov_b32 s63, 0x3fb8aa3b
    v_cmp_gt_u32 s[60:61], 2, v23
    s_waitcnt lgkmcnt(0)
    v_lshlrev_b32 v31, 16, v31
    v_sub_f32 v64, v31, v60
    v_sub_f32 v65, v31, v61
    v_sub_f32 v66, v31, v62
    v_sub_f32 v67, v31, v63
    v_cvt_pk_bf16_f32 v64, 0, v64
    v_cvt_pk_bf16_f32 v65, 0, v65
    v_cvt_pk_bf16_f32 v66, 0, v66
    v_cvt_pk_bf16_f32 v67, 0, v67
    v_mul_f32 v64, v64, v64
    v_mul_f32 v65, v65, v65
    v_mul_f32 v66, v66, v66
    v_mul_f32 v67, v67, v67
    v_cvt_pk_bf16_f32 v64, 0, v64
    v_cvt_pk_bf16_f32 v65, 0, v65
    v_cvt_pk_bf16_f32 v66, 0, v66
    v_cvt_pk_bf16_f32 v67, 0, v67
    v_mul_f32 v64, s62, v64
    v_mul_f32 v65, s62, v65
    v_mul_f32 v66, s62, v66
    v_mul_f32 v67, s62, v67
    v_cvt_pk_bf16_f32 v64, 0, v64
    v_cvt_pk_bf16_f32 v65, 0, v65
    v_cvt_pk_bf16_f32 v66, 0, v66
    v_cvt_pk_bf16_f32 v67, 0, v67
    v_mul_f32 v64, s63, v64
    v_mul_f32 v65, s63, v65
    v_mul_f32 v66, s63, v66
    v_mul_f32 v67, s63, v67
    v_exp_f32 v64, v64
    v_exp_f32 v65, v65
    v_exp_f32 v66, v66
    v_exp_f32 v67, v67
    s_nop 0
    v_cvt_pk_bf16_f32 v46, v64, v65
    v_cvt_pk_bf16_f32 v47, v66, v67
    v_cndmask_b32 v46, 0, v46, s[60:61]
    v_cndmask_b32 v47, 0, v47, s[60:61]
    v_cvt_pk_bf16_f32 v68, v68, v69
    v_cvt_pk_bf16_f32 v69, v70, v71
    v_cvt_pk_bf16_f32 v72, v72, v73
    v_cvt_pk_bf16_f32 v73, v74, v75
    v_cvt_pk_bf16_f32 v76, v76, v77
    v_cvt_pk_bf16_f32 v77, v78, v79
    s_nop 1
    v_mfma_f32_16x16x16_bf16 v[4:7], v[48:49], v[68:69], 0
    v_mfma_f32_16x16x16_bf16 v[8:11], v[48:49], v[72:73], 0
    v_mfma_f32_16x16x16_bf16 v[12:15], v[48:49], v[76:77], 0
    v_mfma_f32_16x16x16_bf16 v[16:19], v[54:55], v[46:47], 0
    v_mfma_f32_16x16x16_bf16 v[24:27], v[56:57], v[46:47], 0
    v_mfma_f32_16x16x16_bf16 v[64:67], v[58:59], v[46:47], 0
    v_mfma_f32_16x16x16_bf16 v[72:75], v[52:53], v[46:47], 0
    s_nop 7
    v_mul_f32 v4, v4, v16
    v_mul_f32 v5, v5, v17
    v_mul_f32 v6, v6, v18
    v_mul_f32 v7, v7, v19
    v_fma_f32 v4, v8, v24, v4
    v_fma_f32 v5, v9, v25, v5
    v_fma_f32 v6, v10, v26, v6
    v_fma_f32 v7, v11, v27, v7
    v_fma_f32 v4, v12, v64, v4
    v_fma_f32 v5, v13, v65, v5
    v_fma_f32 v6, v14, v66, v6
    v_fma_f32 v7, v15, v67, v7
    v_cvt_pk_bf16_f32 v8, v4, v5
    v_cvt_pk_bf16_f32 v9, v6, v7
    s_nop 1
    v_mfma_f32_16x16x16_bf16 v[12:15], v[50:51], v[8:9], 0
    v_cvt_pk_bf16_f32 v72, 0, v72
    v_cvt_pk_bf16_f32 v73, 0, v73
    v_cvt_pk_bf16_f32 v74, 0, v74
    v_cvt_pk_bf16_f32 v75, 0, v75
    v_lshlrev_b32 v16, 16, v36
    v_and_b32 v17, 0xffff0000, v36
    v_lshlrev_b32 v18, 16, v37
    v_and_b32 v19, 0xffff0000, v37
    s_nop 1
    v_cvt_pk_bf16_f32 v12, 0, v12
    v_cvt_pk_bf16_f32 v13, 0, v13
    v_cvt_pk_bf16_f32 v14, 0, v14
    v_cvt_pk_bf16_f32 v15, 0, v15
    v_mul_f32 v12, v12, v72
    v_mul_f32 v13, v13, v73
    v_mul_f32 v14, v14, v74
    v_mul_f32 v15, v15, v75
    v_cvt_pk_bf16_f32 v12, 0, v12
    v_cvt_pk_bf16_f32 v13, 0, v13
    v_cvt_pk_bf16_f32 v14, 0, v14
    v_cvt_pk_bf16_f32 v15, 0, v15
    v_add_f32 v12, v12, v16
    v_add_f32 v13, v13, v17
    v_add_f32 v14, v14, v18
    v_add_f32 v15, v15, v19
    v_cvt_pk_bf16_f32 v36, v12, v13
    v_cvt_pk_bf16_f32 v37, v14, v15
    buffer_store_dwordx2 v[36:37], v30, s[44:47], 0 offen offset:0
    v_lshlrev_b32 v32, 16, v32
    v_sub_f32 v64, v32, v60
    v_sub_f32 v65, v32, v61
    v_sub_f32 v66, v32, v62
    v_sub_f32 v67, v32, v63
    v_cvt_pk_bf16_f32 v64, 0, v64
    v_cvt_pk_bf16_f32 v65, 0, v65
    v_cvt_pk_bf16_f32 v66, 0, v66
    v_cvt_pk_bf16_f32 v67, 0, v67
    v_mul_f32 v64, v64, v64
    v_mul_f32 v65, v65, v65
    v_mul_f32 v66, v66, v66
    v_mul_f32 v67, v67, v67
    v_cvt_pk_bf16_f32 v64, 0, v64
    v_cvt_pk_bf16_f32 v65, 0, v65
    v_cvt_pk_bf16_f32 v66, 0, v66
    v_cvt_pk_bf16_f32 v67, 0, v67
    v_mul_f32 v64, s62, v64
    v_mul_f32 v65, s62, v65
    v_mul_f32 v66, s62, v66
    v_mul_f32 v67, s62, v67
    v_cvt_pk_bf16_f32 v64, 0, v64
    v_cvt_pk_bf16_f32 v65, 0, v65
    v_cvt_pk_bf16_f32 v66, 0, v66
    v_cvt_pk_bf16_f32 v67, 0, v67
    v_mul_f32 v64, s63, v64
    v_mul_f32 v65, s63, v65
    v_mul_f32 v66, s63, v66
    v_mul_f32 v67, s63, v67
    v_exp_f32 v64, v64
    v_exp_f32 v65, v65
    v_exp_f32 v66, v66
    v_exp_f32 v67, v67
    s_nop 0
    v_cvt_pk_bf16_f32 v46, v64, v65
    v_cvt_pk_bf16_f32 v47, v66, v67
    v_cndmask_b32 v46, 0, v46, s[60:61]
    v_cndmask_b32 v47, 0, v47, s[60:61]
    v_cvt_pk_bf16_f32 v80, v80, v81
    v_cvt_pk_bf16_f32 v81, v82, v83
    v_cvt_pk_bf16_f32 v84, v84, v85
    v_cvt_pk_bf16_f32 v85, v86, v87
    v_cvt_pk_bf16_f32 v88, v88, v89
    v_cvt_pk_bf16_f32 v89, v90, v91
    s_nop 1
    v_mfma_f32_16x16x16_bf16 v[4:7], v[48:49], v[80:81], 0
    v_mfma_f32_16x16x16_bf16 v[8:11], v[48:49], v[84:85], 0
    v_mfma_f32_16x16x16_bf16 v[12:15], v[48:49], v[88:89], 0
    v_mfma_f32_16x16x16_bf16 v[16:19], v[54:55], v[46:47], 0
    v_mfma_f32_16x16x16_bf16 v[24:27], v[56:57], v[46:47], 0
    v_mfma_f32_16x16x16_bf16 v[64:67], v[58:59], v[46:47], 0
    v_mfma_f32_16x16x16_bf16 v[84:87], v[52:53], v[46:47], 0
    s_nop 7
    v_mul_f32 v4, v4, v16
    v_mul_f32 v5, v5, v17
    v_mul_f32 v6, v6, v18
    v_mul_f32 v7, v7, v19
    v_fma_f32 v4, v8, v24, v4
    v_fma_f32 v5, v9, v25, v5
    v_fma_f32 v6, v10, v26, v6
    v_fma_f32 v7, v11, v27, v7
    v_fma_f32 v4, v12, v64, v4
    v_fma_f32 v5, v13, v65, v5
    v_fma_f32 v6, v14, v66, v6
    v_fma_f32 v7, v15, v67, v7
    v_cvt_pk_bf16_f32 v8, v4, v5
    v_cvt_pk_bf16_f32 v9, v6, v7
    s_nop 1
    v_mfma_f32_16x16x16_bf16 v[12:15], v[50:51], v[8:9], 0
    v_cvt_pk_bf16_f32 v84, 0, v84
    v_cvt_pk_bf16_f32 v85, 0, v85
    v_cvt_pk_bf16_f32 v86, 0, v86
    v_cvt_pk_bf16_f32 v87, 0, v87
    v_lshlrev_b32 v16, 16, v38
    v_and_b32 v17, 0xffff0000, v38
    v_lshlrev_b32 v18, 16, v39
    v_and_b32 v19, 0xffff0000, v39
    s_nop 1
    v_cvt_pk_bf16_f32 v12, 0, v12
    v_cvt_pk_bf16_f32 v13, 0, v13
    v_cvt_pk_bf16_f32 v14, 0, v14
    v_cvt_pk_bf16_f32 v15, 0, v15
    v_mul_f32 v12, v12, v84
    v_mul_f32 v13, v13, v85
    v_mul_f32 v14, v14, v86
    v_mul_f32 v15, v15, v87
    v_cvt_pk_bf16_f32 v12, 0, v12
    v_cvt_pk_bf16_f32 v13, 0, v13
    v_cvt_pk_bf16_f32 v14, 0, v14
    v_cvt_pk_bf16_f32 v15, 0, v15
    v_add_f32 v12, v12, v16
    v_add_f32 v13, v13, v17
    v_add_f32 v14, v14, v18
    v_add_f32 v15, v15, v19
    v_cvt_pk_bf16_f32 v38, v12, v13
    v_cvt_pk_bf16_f32 v39, v14, v15
    buffer_store_dwordx2 v[38:39], v30, s[44:47], 0 offen offset:512
    v_lshlrev_b32 v33, 16, v33
    v_sub_f32 v64, v33, v60
    v_sub_f32 v65, v33, v61
    v_sub_f32 v66, v33, v62
    v_sub_f32 v67, v33, v63
    v_cvt_pk_bf16_f32 v64, 0, v64
    v_cvt_pk_bf16_f32 v65, 0, v65
    v_cvt_pk_bf16_f32 v66, 0, v66
    v_cvt_pk_bf16_f32 v67, 0, v67
    v_mul_f32 v64, v64, v64
    v_mul_f32 v65, v65, v65
    v_mul_f32 v66, v66, v66
    v_mul_f32 v67, v67, v67
    v_cvt_pk_bf16_f32 v64, 0, v64
    v_cvt_pk_bf16_f32 v65, 0, v65
    v_cvt_pk_bf16_f32 v66, 0, v66
    v_cvt_pk_bf16_f32 v67, 0, v67
    v_mul_f32 v64, s62, v64
    v_mul_f32 v65, s62, v65
    v_mul_f32 v66, s62, v66
    v_mul_f32 v67, s62, v67
    v_cvt_pk_bf16_f32 v64, 0, v64
    v_cvt_pk_bf16_f32 v65, 0, v65
    v_cvt_pk_bf16_f32 v66, 0, v66
    v_cvt_pk_bf16_f32 v67, 0, v67
    v_mul_f32 v64, s63, v64
    v_mul_f32 v65, s63, v65
    v_mul_f32 v66, s63, v66
    v_mul_f32 v67, s63, v67
    v_exp_f32 v64, v64
    v_exp_f32 v65, v65
    v_exp_f32 v66, v66
    v_exp_f32 v67, v67
    s_nop 0
    v_cvt_pk_bf16_f32 v46, v64, v65
    v_cvt_pk_bf16_f32 v47, v66, v67
    v_cndmask_b32 v46, 0, v46, s[60:61]
    v_cndmask_b32 v47, 0, v47, s[60:61]
    v_cvt_pk_bf16_f32 v92, v92, v93
    v_cvt_pk_bf16_f32 v93, v94, v95
    v_cvt_pk_bf16_f32 v96, v96, v97
    v_cvt_pk_bf16_f32 v97, v98, v99
    v_cvt_pk_bf16_f32 v100, v100, v101
    v_cvt_pk_bf16_f32 v101, v102, v103
    s_nop 1
    v_mfma_f32_16x16x16_bf16 v[4:7], v[48:49], v[92:93], 0
    v_mfma_f32_16x16x16_bf16 v[8:11], v[48:49], v[96:97], 0
    v_mfma_f32_16x16x16_bf16 v[12:15], v[48:49], v[100:101], 0
    v_mfma_f32_16x16x16_bf16 v[16:19], v[54:55], v[46:47], 0
    v_mfma_f32_16x16x16_bf16 v[24:27], v[56:57], v[46:47], 0
    v_mfma_f32_16x16x16_bf16 v[64:67], v[58:59], v[46:47], 0
    v_mfma_f32_16x16x16_bf16 v[96:99], v[52:53], v[46:47], 0
    s_nop 7
    v_mul_f32 v4, v4, v16
    v_mul_f32 v5, v5, v17
    v_mul_f32 v6, v6, v18
    v_mul_f32 v7, v7, v19
    v_fma_f32 v4, v8, v24, v4
    v_fma_f32 v5, v9, v25, v5
    v_fma_f32 v6, v10, v26, v6
    v_fma_f32 v7, v11, v27, v7
    v_fma_f32 v4, v12, v64, v4
    v_fma_f32 v5, v13, v65, v5
    v_fma_f32 v6, v14, v66, v6
    v_fma_f32 v7, v15, v67, v7
    v_cvt_pk_bf16_f32 v8, v4, v5
    v_cvt_pk_bf16_f32 v9, v6, v7
    s_nop 1
    v_mfma_f32_16x16x16_bf16 v[12:15], v[50:51], v[8:9], 0
    v_cvt_pk_bf16_f32 v96, 0, v96
    v_cvt_pk_bf16_f32 v97, 0, v97
    v_cvt_pk_bf16_f32 v98, 0, v98
    v_cvt_pk_bf16_f32 v99, 0, v99
    v_lshlrev_b32 v16, 16, v40
    v_and_b32 v17, 0xffff0000, v40
    v_lshlrev_b32 v18, 16, v41
    v_and_b32 v19, 0xffff0000, v41
    s_nop 1
    v_cvt_pk_bf16_f32 v12, 0, v12
    v_cvt_pk_bf16_f32 v13, 0, v13
    v_cvt_pk_bf16_f32 v14, 0, v14
    v_cvt_pk_bf16_f32 v15, 0, v15
    v_mul_f32 v12, v12, v96
    v_mul_f32 v13, v13, v97
    v_mul_f32 v14, v14, v98
    v_mul_f32 v15, v15, v99
    v_cvt_pk_bf16_f32 v12, 0, v12
    v_cvt_pk_bf16_f32 v13, 0, v13
    v_cvt_pk_bf16_f32 v14, 0, v14
    v_cvt_pk_bf16_f32 v15, 0, v15
    v_add_f32 v12, v12, v16
    v_add_f32 v13, v13, v17
    v_add_f32 v14, v14, v18
    v_add_f32 v15, v15, v19
    v_cvt_pk_bf16_f32 v40, v12, v13
    v_cvt_pk_bf16_f32 v41, v14, v15
    buffer_store_dwordx2 v[40:41], v30, s[44:47], 0 offen offset:1024
    v_lshlrev_b32 v34, 16, v34
    v_sub_f32 v64, v34, v60
    v_sub_f32 v65, v34, v61
    v_sub_f32 v66, v34, v62
    v_sub_f32 v67, v34, v63
    v_cvt_pk_bf16_f32 v64, 0, v64
    v_cvt_pk_bf16_f32 v65, 0, v65
    v_cvt_pk_bf16_f32 v66, 0, v66
    v_cvt_pk_bf16_f32 v67, 0, v67
    v_mul_f32 v64, v64, v64
    v_mul_f32 v65, v65, v65
    v_mul_f32 v66, v66, v66
    v_mul_f32 v67, v67, v67
    v_cvt_pk_bf16_f32 v64, 0, v64
    v_cvt_pk_bf16_f32 v65, 0, v65
    v_cvt_pk_bf16_f32 v66, 0, v66
    v_cvt_pk_bf16_f32 v67, 0, v67
    v_mul_f32 v64, s62, v64
    v_mul_f32 v65, s62, v65
    v_mul_f32 v66, s62, v66
    v_mul_f32 v67, s62, v67
    v_cvt_pk_bf16_f32 v64, 0, v64
    v_cvt_pk_bf16_f32 v65, 0, v65
    v_cvt_pk_bf16_f32 v66, 0, v66
    v_cvt_pk_bf16_f32 v67, 0, v67
    v_mul_f32 v64, s63, v64
    v_mul_f32 v65, s63, v65
    v_mul_f32 v66, s63, v66
    v_mul_f32 v67, s63, v67
    v_exp_f32 v64, v64
    v_exp_f32 v65, v65
    v_exp_f32 v66, v66
    v_exp_f32 v67, v67
    s_nop 0
    v_cvt_pk_bf16_f32 v46, v64, v65
    v_cvt_pk_bf16_f32 v47, v66, v67
    v_cndmask_b32 v46, 0, v46, s[60:61]
    v_cndmask_b32 v47, 0, v47, s[60:61]
    v_cvt_pk_bf16_f32 v104, v104, v105
    v_cvt_pk_bf16_f32 v105, v106, v107
    v_cvt_pk_bf16_f32 v108, v108, v109
    v_cvt_pk_bf16_f32 v109, v110, v111
    v_cvt_pk_bf16_f32 v112, v112, v113
    v_cvt_pk_bf16_f32 v113, v114, v115
    s_nop 1
    v_mfma_f32_16x16x16_bf16 v[4:7], v[48:49], v[104:105], 0
    v_mfma_f32_16x16x16_bf16 v[8:11], v[48:49], v[108:109], 0
    v_mfma_f32_16x16x16_bf16 v[12:15], v[48:49], v[112:113], 0
    v_mfma_f32_16x16x16_bf16 v[16:19], v[54:55], v[46:47], 0
    v_mfma_f32_16x16x16_bf16 v[24:27], v[56:57], v[46:47], 0
    v_mfma_f32_16x16x16_bf16 v[64:67], v[58:59], v[46:47], 0
    v_mfma_f32_16x16x16_bf16 v[108:111], v[52:53], v[46:47], 0
    s_nop 7
    v_mul_f32 v4, v4, v16
    v_mul_f32 v5, v5, v17
    v_mul_f32 v6, v6, v18
    v_mul_f32 v7, v7, v19
    v_fma_f32 v4, v8, v24, v4
    v_fma_f32 v5, v9, v25, v5
    v_fma_f32 v6, v10, v26, v6
    v_fma_f32 v7, v11, v27, v7
    v_fma_f32 v4, v12, v64, v4
    v_fma_f32 v5, v13, v65, v5
    v_fma_f32 v6, v14, v66, v6
    v_fma_f32 v7, v15, v67, v7
    v_cvt_pk_bf16_f32 v8, v4, v5
    v_cvt_pk_bf16_f32 v9, v6, v7
    s_nop 1
    v_mfma_f32_16x16x16_bf16 v[12:15], v[50:51], v[8:9], 0
    v_cvt_pk_bf16_f32 v108, 0, v108
    v_cvt_pk_bf16_f32 v109, 0, v109
    v_cvt_pk_bf16_f32 v110, 0, v110
    v_cvt_pk_bf16_f32 v111, 0, v111
    v_lshlrev_b32 v16, 16, v42
    v_and_b32 v17, 0xffff0000, v42
    v_lshlrev_b32 v18, 16, v43
    v_and_b32 v19, 0xffff0000, v43
    s_nop 1
    v_cvt_pk_bf16_f32 v12, 0, v12
    v_cvt_pk_bf16_f32 v13, 0, v13
    v_cvt_pk_bf16_f32 v14, 0, v14
    v_cvt_pk_bf16_f32 v15, 0, v15
    v_mul_f32 v12, v12, v108
    v_mul_f32 v13, v13, v109
    v_mul_f32 v14, v14, v110
    v_mul_f32 v15, v15, v111
    v_cvt_pk_bf16_f32 v12, 0, v12
    v_cvt_pk_bf16_f32 v13, 0, v13
    v_cvt_pk_bf16_f32 v14, 0, v14
    v_cvt_pk_bf16_f32 v15, 0, v15
    v_add_f32 v12, v12, v16
    v_add_f32 v13, v13, v17
    v_add_f32 v14, v14, v18
    v_add_f32 v15, v15, v19
    v_cvt_pk_bf16_f32 v42, v12, v13
    v_cvt_pk_bf16_f32 v43, v14, v15
    buffer_store_dwordx2 v[42:43], v30, s[44:47], 0 offen offset:1536
    v_lshlrev_b32 v35, 16, v35
    v_sub_f32 v64, v35, v60
    v_sub_f32 v65, v35, v61
    v_sub_f32 v66, v35, v62
    v_sub_f32 v67, v35, v63
    v_cvt_pk_bf16_f32 v64, 0, v64
    v_cvt_pk_bf16_f32 v65, 0, v65
    v_cvt_pk_bf16_f32 v66, 0, v66
    v_cvt_pk_bf16_f32 v67, 0, v67
    v_mul_f32 v64, v64, v64
    v_mul_f32 v65, v65, v65
    v_mul_f32 v66, v66, v66
    v_mul_f32 v67, v67, v67
    v_cvt_pk_bf16_f32 v64, 0, v64
    v_cvt_pk_bf16_f32 v65, 0, v65
    v_cvt_pk_bf16_f32 v66, 0, v66
    v_cvt_pk_bf16_f32 v67, 0, v67
    v_mul_f32 v64, s62, v64
    v_mul_f32 v65, s62, v65
    v_mul_f32 v66, s62, v66
    v_mul_f32 v67, s62, v67
    v_cvt_pk_bf16_f32 v64, 0, v64
    v_cvt_pk_bf16_f32 v65, 0, v65
    v_cvt_pk_bf16_f32 v66, 0, v66
    v_cvt_pk_bf16_f32 v67, 0, v67
    v_mul_f32 v64, s63, v64
    v_mul_f32 v65, s63, v65
    v_mul_f32 v66, s63, v66
    v_mul_f32 v67, s63, v67
    v_exp_f32 v64, v64
    v_exp_f32 v65, v65
    v_exp_f32 v66, v66
    v_exp_f32 v67, v67
    s_nop 0
    v_cvt_pk_bf16_f32 v46, v64, v65
    v_cvt_pk_bf16_f32 v47, v66, v67
    v_cndmask_b32 v46, 0, v46, s[60:61]
    v_cndmask_b32 v47, 0, v47, s[60:61]
    v_cvt_pk_bf16_f32 v116, v116, v117
    v_cvt_pk_bf16_f32 v117, v118, v119
    v_cvt_pk_bf16_f32 v120, v120, v121
    v_cvt_pk_bf16_f32 v121, v122, v123
    v_cvt_pk_bf16_f32 v124, v124, v125
    v_cvt_pk_bf16_f32 v125, v126, v127
    s_nop 1
    v_mfma_f32_16x16x16_bf16 v[4:7], v[48:49], v[116:117], 0
    v_mfma_f32_16x16x16_bf16 v[8:11], v[48:49], v[120:121], 0
    v_mfma_f32_16x16x16_bf16 v[12:15], v[48:49], v[124:125], 0
    v_mfma_f32_16x16x16_bf16 v[16:19], v[54:55], v[46:47], 0
    v_mfma_f32_16x16x16_bf16 v[24:27], v[56:57], v[46:47], 0
    v_mfma_f32_16x16x16_bf16 v[64:67], v[58:59], v[46:47], 0
    v_mfma_f32_16x16x16_bf16 v[120:123], v[52:53], v[46:47], 0
    s_nop 7
    v_mul_f32 v4, v4, v16
    v_mul_f32 v5, v5, v17
    v_mul_f32 v6, v6, v18
    v_mul_f32 v7, v7, v19
    v_fma_f32 v4, v8, v24, v4
    v_fma_f32 v5, v9, v25, v5
    v_fma_f32 v6, v10, v26, v6
    v_fma_f32 v7, v11, v27, v7
    v_fma_f32 v4, v12, v64, v4
    v_fma_f32 v5, v13, v65, v5
    v_fma_f32 v6, v14, v66, v6
    v_fma_f32 v7, v15, v67, v7
    v_cvt_pk_bf16_f32 v8, v4, v5
    v_cvt_pk_bf16_f32 v9, v6, v7
    s_nop 1
    v_mfma_f32_16x16x16_bf16 v[12:15], v[50:51], v[8:9], 0
    v_cvt_pk_bf16_f32 v120, 0, v120
    v_cvt_pk_bf16_f32 v121, 0, v121
    v_cvt_pk_bf16_f32 v122, 0, v122
    v_cvt_pk_bf16_f32 v123, 0, v123
    v_lshlrev_b32 v16, 16, v44
    v_and_b32 v17, 0xffff0000, v44
    v_lshlrev_b32 v18, 16, v45
    v_and_b32 v19, 0xffff0000, v45
    s_nop 1
    v_cvt_pk_bf16_f32 v12, 0, v12
    v_cvt_pk_bf16_f32 v13, 0, v13
    v_cvt_pk_bf16_f32 v14, 0, v14
    v_cvt_pk_bf16_f32 v15, 0, v15
    v_mul_f32 v12, v12, v120
    v_mul_f32 v13, v13, v121
    v_mul_f32 v14, v14, v122
    v_mul_f32 v15, v15, v123
    v_cvt_pk_bf16_f32 v12, 0, v12
    v_cvt_pk_bf16_f32 v13, 0, v13
    v_cvt_pk_bf16_f32 v14, 0, v14
    v_cvt_pk_bf16_f32 v15, 0, v15
    v_add_f32 v12, v12, v16
    v_add_f32 v13, v13, v17
    v_add_f32 v14, v14, v18
    v_add_f32 v15, v15, v19
    v_cvt_pk_bf16_f32 v44, v12, v13
    v_cvt_pk_bf16_f32 v45, v14, v15
    buffer_store_dwordx2 v[44:45], v30, s[44:47], 0 offen offset:2048
L_p2_end:
    s_endpgm
.section .rodata,"a"
.p2align 6
.amdhsa_kernel partition_kernel
  .amdhsa_next_free_vgpr 128
  .amdhsa_next_free_sgpr 100
  .amdhsa_accum_offset 128
  .amdhsa_group_segment_fixed_size 0
  .amdhsa_kernarg_size 112
  .amdhsa_user_sgpr_count 2
  .amdhsa_user_sgpr_kernarg_segment_ptr 1
  .amdhsa_system_sgpr_workgroup_id_x 1
.end_amdhsa_kernel
.p2align 6
.amdhsa_kernel consume_kernel
  .amdhsa_next_free_vgpr 128
  .amdhsa_next_free_sgpr 80
  .amdhsa_accum_offset 128
  .amdhsa_group_segment_fixed_size 0
  .amdhsa_kernarg_size 112
  .amdhsa_user_sgpr_count 2
  .amdhsa_user_sgpr_kernarg_segment_ptr 1
  .amdhsa_system_sgpr_workgroup_id_x 1
.end_amdhsa_kernel
```
